```python
import torch

def _softmax(x, axis=-1):
    return torch.softmax(x, dim=axis)

def _gelu(x):
    return torch.nn.functional.gelu(x, approximate='tanh')

def _silu(x):
    return torch.nn.functional.silu(x)

def _sigmoid(x):
    return torch.sigmoid(x)

def _layernorm(x, axis=-1, eps=1e-05):
    m = x.mean(dim=axis, keepdim=True)
    v = x.var(dim=axis, keepdim=True, unbiased=False)
    return (x - m) / torch.sqrt(v + eps)

def _scatter_add(tgt, idx, src, axis=0):
    return tgt.clone().index_add_(axis, idx, src)

def _segment_sum(src, seg, n):
    out = torch.zeros((n,) + src.shape[1:], dtype=src.dtype)
    return out.index_add_(0, seg, src)

def _pad(x, pw):
    flat = tuple((v for pair in reversed(pw) for v in pair))
    return torch.nn.functional.pad(x, flat)
kernel_name = 'adaLN_cond__sliding_block_cached__dense_activation_silu__decode'

def setup_inputs():

    _w = lambda a: (lambda t: t.to(torch.bfloat16) if t.is_floating_point() else t)(torch.as_tensor(a))

    def _A_setup():
        B, Sq, D = (2, 1, 448)
        Hq, Hkv, Sk, Dh = (16, 8, 8192, 256)
        assert Hq % Hkv == 0, (Hq, Hkv)
        return {'x': _w((lambda *s: torch.randn(*s, dtype=torch.bfloat16) * 0.1)(B, Sq, D)), 'k_cache': _w((lambda *s: torch.randn(*s, dtype=torch.bfloat16) * 0.8)(B, Hkv, Sk, Dh)), 'v_cache': _w((lambda *s: torch.randn(*s, dtype=torch.bfloat16) * 3.2)(B, Hkv, Sk, Dh)), 'wq': _w((lambda *s: torch.randn(*s, dtype=torch.bfloat16) * 0.8)(D, Hq * Dh) * D ** (-0.5)), 'wo': _w((lambda *s: torch.randn(*s, dtype=torch.bfloat16) * 3.2)(Hq * Dh, D) * (Hq * Dh) ** (-0.5))}
    _A_in = _A_setup()

    def _B_setup():
        B, S, D, F = (2, 1, 448, 1792)
        return {'x': _w((lambda *s: torch.randn(*s, dtype=torch.bfloat16) * 0.1)(B, S, D)), 'w1': _w((lambda *s: torch.randn(*s, dtype=torch.bfloat16) * 3.2)(D, F) * D ** (-0.5)), 'w2': _w((lambda *s: torch.randn(*s, dtype=torch.bfloat16) * 3.2)(F, D) * F ** (-0.5))}
    _B_in = _B_setup()
    return {'A_x': _A_in['x'], 'A_k_cache': _A_in['k_cache'], 'A_v_cache': _A_in['v_cache'], 'A_wq': _A_in['wq'], 'A_wo': _A_in['wo'], 'B_x': _B_in['x'], 'B_w1': _B_in['w1'], 'B_w2': _B_in['w2'], 'c': _w((lambda *s: torch.randn(*s, dtype=torch.bfloat16) * 0.2)(2, 448) * 8.0), 'w_mod': _w((lambda *s: torch.randn(*s, dtype=torch.bfloat16) * 0.2)(448, 6 * 448) * 448 ** (-0.5) * 8.0)}

def reference(A_x, A_k_cache, A_v_cache, A_wq, A_wo, B_x, B_w1, B_w2, c, w_mod):

    def _A_ref(x, k_cache, v_cache, wq, wo):
        B, Sq, D = x.shape
        Hq, Dh = (16, 256)
        Hkv, Sk = (k_cache.shape[1], k_cache.shape[2])
        W = min(4096, max(256, Sk // 4))
        rep = Hq // Hkv
        q = (lambda x, *d: x.permute(*d))((x @ wq).reshape(B, Sq, Hq, Dh), 0, 2, 1, 3)
        k = (lambda x, n, axis: torch.repeat_interleave(x, n, dim=axis))(k_cache[:, :, Sk - W:, :], rep, axis=1)
        v = (lambda x, n, axis: torch.repeat_interleave(x, n, dim=axis))(v_cache[:, :, Sk - W:, :], rep, axis=1)
        scores = torch.einsum('bhqd,bhkd->bhqk', q, k) * Dh ** (-0.5)
        p = _softmax(scores, axis=-1)
        o = torch.einsum('bhqk,bhkd->bhqd', p, v)
        return (lambda x, *d: x.permute(*d))(o, 0, 2, 1, 3).reshape(B, Sq, Hq * Dh) @ wo

    def _B_ref(x, w1, w2):
        h = torch.einsum('bsd,df->bsf', x, w1)
        h = _silu(h)
        out = torch.einsum('bsf,fd->bsd', h, w2)
        return out
    x = A_x
    mod = (_silu(c) @ w_mod).reshape(c.shape[0], 6, 1, -1)
    sa, ca, ga, sb, cb, gb = (mod[:, 0].clone(), mod[:, 1].clone(), mod[:, 2].clone(), mod[:, 3].clone(), mod[:, 4].clone(), mod[:, 5].clone())
    h = _layernorm(x, axis=-1) * (1 + ca) + sa
    x = x + ga * _A_ref(h, A_k_cache, A_v_cache, A_wq, A_wo)
    h = _layernorm(x, axis=-1) * (1 + cb) + sb
    x = x + gb * _B_ref(h, B_w1, B_w2)
    return x
```

```asm
; @launch grid=(256,1,1) block=(1024,1,1) lds=135168
.amdgcn_target "amdgcn-amd-amdhsa--gfx950"
.text
.globl adaLN_cond__sliding_block_cached__dense_activation_silu__decode_kernel
.p2align 8
.type adaLN_cond__sliding_block_cached__dense_activation_silu__decode_kernel,@function
adaLN_cond__sliding_block_cached__dense_activation_silu__decode_kernel:
  s_load_dwordx16 s[32:47], s[0:1], 0
  s_load_dwordx8 s[48:55], s[0:1], 64
  s_load_dwordx2 s[56:57], s[0:1], 96
  s_cmp_ge_u32 s2, 256
  s_cbranch_scc1 L_exit
  v_lshrrev_b32 v14, 6, v0
  v_and_b32 v1, 63, v0
  v_and_b32 v2, 15, v0
  v_readfirstlane_b32 s3, v14
  v_lshrrev_b32 v3, 4, v1
  s_and_b32 s4, s2, 7
  s_xor_b32 s4, s4, 7
  s_lshr_b32 s5, s2, 3
  s_mul_i32 s24, s5, 7
  s_add_u32 s24, s24, s4
  s_mov_b32 s18, 0x10000000
  s_mov_b32 s19, 0x20000
  s_cmp_eq_u32 s4, 7
  s_cbranch_scc1 L_m
  s_cmp_ge_u32 s24, 160
  s_cbranch_scc1 L_q
L_att:
  s_and_b32 s4, s24, 15
  s_lshr_b32 s5, s24, 4
  s_mov_b32 s25, 9
  s_mov_b32 s7, 0
  s_cmp_ge_u32 s5, 4
  s_cselect_b32 s25, 12, s25
  s_cselect_b32 s7, -12, s7
  s_cmp_ge_u32 s5, 10
  s_cselect_b32 s25, 5, s25
  s_cselect_b32 s7, 58, s7
  s_mul_i32 s6, s5, s25
  s_add_u32 s7, s7, s6
  s_add_u32 s7, s7, s3
  s_lshl_b32 s7, s7, 4
  s_lshl_b32 s6, s4, 13
  s_add_u32 s6, s6, s7
  s_add_u32 s6, s6, 6144
  s_lshl_b32 s6, s6, 9
  s_add_u32 s7, s6, 4096
  s_mov_b32 s10, 0x4000000
  s_mov_b32 s11, 0x20000
  s_mov_b32 s14, 0x4000000
  s_mov_b32 s15, 0x20000
  v_lshrrev_b32 v4, 1, v2
  v_lshlrev_b32 v4, 9, v4
  v_and_b32 v5, 1, v2
  v_lshl_add_u32 v4, v5, 6, v4
  v_lshl_add_u32 v4, v3, 4, v4
  v_lshlrev_b32 v5, 10, v3
  v_lshl_add_u32 v5, v2, 4, v5
  s_cmp_ge_u32 s24, 160
  s_cselect_b32 s26, 0, 0
  s_cmp_ge_u32 s3, s26
  s_cbranch_scc1 L_a_clr
  s_waitcnt lgkmcnt(0)
L_a_ld:
  s_mov_b32 s8, s34
  s_mov_b32 s9, s35
  buffer_load_dwordx4 v[16:19], v4, s[8:11], s6 offen offset:0 nt
  buffer_load_dwordx4 v[20:23], v4, s[8:11], s6 offen offset:128 nt
  buffer_load_dwordx4 v[24:27], v4, s[8:11], s6 offen offset:256 nt
  buffer_load_dwordx4 v[28:31], v4, s[8:11], s6 offen offset:384 nt
  buffer_load_dwordx4 v[32:35], v4, s[8:11], s7 offen offset:0 nt
  buffer_load_dwordx4 v[36:39], v4, s[8:11], s7 offen offset:128 nt
  buffer_load_dwordx4 v[40:43], v4, s[8:11], s7 offen offset:256 nt
  buffer_load_dwordx4 v[44:47], v4, s[8:11], s7 offen offset:384 nt
  s_mov_b32 s12, s36
  s_mov_b32 s13, s37
  buffer_load_dwordx4 v[48:51], v5, s[12:15], s6 offen offset:0 nt
  buffer_load_dwordx4 v[52:55], v5, s[12:15], s6 offen offset:256 nt
  buffer_load_dwordx4 v[56:59], v5, s[12:15], s6 offen offset:512 nt
  buffer_load_dwordx4 v[60:63], v5, s[12:15], s6 offen offset:768 nt
  buffer_load_dwordx4 v[64:67], v5, s[12:15], s7 offen offset:0 nt
  buffer_load_dwordx4 v[68:71], v5, s[12:15], s7 offen offset:256 nt
  buffer_load_dwordx4 v[72:75], v5, s[12:15], s7 offen offset:512 nt
  buffer_load_dwordx4 v[76:79], v5, s[12:15], s7 offen offset:768 nt
  s_cmp_ge_u32 s3, s26
  s_cbranch_scc1 L_a_cont
L_a_clr:
  s_lshl_b32 s30, s3, 4
  s_add_u32 s30, s30, 91656
  v_lshlrev_b32 v12, 8, v1
  v_add_u32 v12, s30, v12
  s_lshl_b32 s30, s3, 2
  s_add_u32 s30, s30, 92160
  v_mov_b32 v6, s30
  v_mov_b32 v13, 0
  s_lshl_b32 s30, s3, 4
  s_add_u32 s30, s30, 133888
  v_lshlrev_b32 v14, 3, v1
  v_add_u32 v14, s30, v14
  v_mov_b32 v122, -1
  v_mov_b32 v123, -1
  s_mov_b64 exec, 3
  ds_write_b32 v12, v13
  ds_write_b32 v6, v13
  ds_write_b64 v14, v[122:123]
  s_mov_b64 exec, -1
  s_waitcnt lgkmcnt(0)
  s_barrier
  s_cmp_lt_u32 s3, s26
  s_cbranch_scc1 L_a_cont
  s_cmp_lt_u32 s3, s25
  s_cbranch_scc1 L_a_ld
  s_branch L_a_free
L_m:
  s_add_u32 s24, s5, 196
  s_cmp_ge_u32 s5, 28
  s_cbranch_scc1 L_q
  s_cmp_lg_u32 s3, 15
  s_cbranch_scc1 L_m_nopf
  s_getpc_b64 s[60:61]
L_pc_m:
  s_sub_u32 s60, s60, L_pc_m-adaLN_cond__sliding_block_cached__dense_activation_silu__decode_kernel
  s_subb_u32 s61, s61, 0
  v_lshlrev_b32 v20, 7, v1
  v_add_u32 v21, 0x2000, v20
  v_min_u32 v21, L_exit-adaLN_cond__sliding_block_cached__dense_activation_silu__decode_kernel, v21
  global_load_dword v22, v20, s[60:61]
  global_load_dword v23, v21, s[60:61]
L_m_nopf:
  v_lshrrev_b32 v8, 3, v1
  v_and_b32 v7, 7, v1
  v_and_b32 v14, 1, v3
  v_lshlrev_b32 v14, 1, v14
  v_xor_b32 v7, v7, v14
  v_lshlrev_b32 v7, 4, v7
  s_and_b32 s62, s3, 1
  s_lshl_b32 s62, s62, 6
  v_xor_b32 v14, s62, v7
  v_mul_u32_u24 v15, 5376, v8
  v_add_u32 v14, v14, v15
  s_and_b32 s4, s5, 1
  s_mul_i32 s62, s4, 28
  s_add_u32 s62, s62, s3
  s_mul_i32 s62, s62, 43008
  s_lshr_b32 s61, s5, 1
  s_lshl_b32 s63, s61, 7
  s_add_u32 s62, s62, s63
  s_lshl_b32 m0, s3, 10
  s_mov_b32 s22, 2408448
  s_mov_b32 s23, 0x20000
  s_movk_i32 s26, 1792
  s_mov_b32 s27, 0x20000
  v_lshlrev_b32 v12, 2, v0
  s_waitcnt lgkmcnt(0)
  s_mov_b32 s20, s50
  s_mov_b32 s21, s51
  s_mov_b32 s24, s48
  s_mov_b32 s25, s49
  buffer_load_dword v24, v12, s[24:27], 0 offen
  buffer_load_dwordx4 v14, s[20:23], s62 offen nt lds
  s_cmp_ge_u32 s3, 12
  s_cbranch_scc1 L_m_dma1
  s_add_u32 s62, s62, 688128
  s_add_u32 m0, m0, 16384
  s_nop 0
  buffer_load_dwordx4 v14, s[20:23], s62 offen nt lds
L_m_dma1:
  s_branch L_m_cont
L_q:
  s_sub_u32 s6, s24, 160
  s_mul_i32 s4, s6, 37
  s_lshr_b32 s4, s4, 8
  s_mul_i32 s63, s4, 7
  s_sub_u32 s5, s6, s63
  s_cmp_ge_u32 s5, 3
  s_addc_u32 s64, s5, 0
  s_lshl3_add_u32 s64, s4, s64
  s_mov_b32 s65, 14
  s_mov_b32 s66, 0
  s_mov_b32 s67, 56
  s_mov_b32 s68, 56
  s_cmp_lt_u32 s6, 56
  s_cbranch_scc1 L_q_par
  s_sub_u32 s64, s6, 56
  s_lshl3_add_u32 s64, s64, 3
  s_mov_b32 s65, 9
  s_mov_b32 s67, 36
  s_mov_b32 s68, 36
  s_cmp_lt_u32 s6, 64
  s_cbranch_scc1 L_q_par
  s_sub_u32 s64, s6, 64
  s_lshl4_add_u32 s64, s64, 3
  s_mov_b32 s65, 5
  s_mov_b32 s66, 9
  s_mov_b32 s67, 20
  s_mov_b32 s68, 40
L_q_par:
  s_cmp_ge_u32 s3, 8
  s_cbranch_scc1 L_q_aux
  v_lshrrev_b32 v8, 3, v1
  v_and_b32 v7, 7, v1
  v_and_b32 v14, 1, v3
  v_lshlrev_b32 v14, 1, v14
  v_xor_b32 v7, v7, v14
  v_lshlrev_b32 v7, 4, v7
  s_and_b32 s62, s3, 1
  s_lshl_b32 s62, s62, 6
  v_xor_b32 v14, s62, v7
  v_lshl_add_u32 v14, v8, 13, v14
  s_lshl2_add_u32 s62, s66, s3
  s_lshl_b32 s62, s62, 16
  s_lshl_b32 s63, s64, 7
  s_add_u32 s62, s62, s63
  s_lshl_b32 s63, s67, 16
  s_sub_u32 s63, 1024, s63
  s_lshl_b32 m0, s3, 10
  s_mov_b32 s30, s3
  s_mov_b32 s22, 3670016
  s_mov_b32 s23, 0x20000
  s_waitcnt lgkmcnt(0)
  s_mov_b32 s20, s38
  s_mov_b32 s21, s39
L_q_dma:
  s_cmp_ge_u32 s30, s67
  s_cselect_b32 s31, s63, 0
  s_add_u32 s31, s31, s62
  buffer_load_dwordx4 v14, s[20:23], s31 offen nt lds
  s_add_u32 s62, s62, 0x80000
  s_add_u32 m0, m0, 8192
  s_add_u32 s30, s30, 8
  s_cmp_lt_u32 s30, s68
  s_cbranch_scc1 L_q_dma
  s_branch L_q_cont
L_q_aux:
  s_cmp_lg_u32 s3, 15
  s_cbranch_scc1 L_q_aux1
  s_getpc_b64 s[60:61]
L_pc_q:
  s_sub_u32 s60, s60, L_pc_q-adaLN_cond__sliding_block_cached__dense_activation_silu__decode_kernel
  s_subb_u32 s61, s61, 0
  v_lshlrev_b32 v20, 7, v1
  v_add_u32 v21, 0x2000, v20
  v_min_u32 v21, L_exit-adaLN_cond__sliding_block_cached__dense_activation_silu__decode_kernel, v21
  global_load_dword v22, v20, s[60:61]
  global_load_dword v23, v21, s[60:61]
L_q_aux1:
  s_bfe_u32 s30, s3, 0x10002
  s_mul_i32 s62, s30, 896
  v_lshlrev_b32 v10, 4, v1
  v_mov_b32 v11, 0x10000
  v_cmp_gt_u32 s[70:71], 56, v1
  s_and_b32 s31, s3, 3
  s_mul_i32 s31, s31, 56
  v_add_u32 v4, s31, v1
  v_cndmask_b32 v10, v11, v10, s[70:71]
  v_lshlrev_b32 v5, 2, v4
  s_movk_i32 s22, 1792
  s_mov_b32 s23, 0x20000
  s_waitcnt lgkmcnt(0)
  s_mov_b32 s20, s32
  s_mov_b32 s21, s33
  buffer_load_dwordx4 v[16:19], v10, s[20:23], s62 offen
  buffer_load_dword v24, v5, s[20:23], s62 offen
  s_branch L_qa_cont
L_a_cont:
  s_load_dword s97, s[56:57], 0
  s_mov_b32 s16, s56
  s_mov_b32 s17, s57
  s_cmp_lg_u32 s3, 7
  s_cbranch_scc1 L_nogate
  v_mov_b32 v13, 92196
  v_mov_b32 v14, 1
  ds_write_b32 v13, v14
L_nogate:
  v_lshrrev_b32 v13, 3, v2
  v_bfe_u32 v14, v2, 2, 1
  v_lshlrev_b32 v10, 6, v14
  v_lshl_add_u32 v10, v3, 4, v10
  v_mul_u32_u24 v9, 640, v13
  s_mov_b32 s26, 90112
  v_add3_u32 v9, v9, v10, s26
  v_lshl_add_u32 v10, v13, 7, v10
  v_add_u32 v10, 91392, v10
  v_lshlrev_b32 v12, 8, v13
  s_lshl_b32 s30, s3, 4
  s_add_u32 s30, s30, 91648
  v_add_u32 v12, s30, v12
  v_min_u32 v7, 8, v2
  v_lshlrev_b32 v7, 2, v7
  v_add_u32 v7, 92160, v7
  s_lshl_b32 s30, s3, 11
  s_add_u32 s30, s30, 65536
  v_bfe_u32 v4, v1, 4, 1
  v_lshlrev_b32 v4, 2, v4
  v_xor_b32 v4, v4, v1
  v_lshlrev_b32 v4, 4, v4
  v_add_u32 v4, s30, v4
  v_and_b32 v14, 7, v2
  v_and_b32 v15, 1, v14
  v_lshlrev_b32 v15, 4, v15
  v_mov_b32 v124, 0xffff
  v_lshlrev_b32 v124, v15, v124
  v_lshrrev_b32 v14, 1, v14
  v_cmp_eq_u32 vcc, 0, v14
  s_nop 1
  v_cndmask_b32 v120, 0, v124, vcc
  v_cmp_eq_u32 vcc, 1, v14
  s_nop 1
  v_cndmask_b32 v121, 0, v124, vcc
  v_cmp_eq_u32 vcc, 2, v14
  s_nop 1
  v_cndmask_b32 v122, 0, v124, vcc
  v_cmp_eq_u32 vcc, 3, v14
  s_nop 1
  v_cndmask_b32 v123, 0, v124, vcc
  s_mov_b32 s27, 0x3db8aa3b
  s_mov_b32 s20, 4283707920
  s_mov_b32 s21, 4287102831
  s_cmp_ge_u32 s5, 4
  s_cselect_b32 s20, 4294193680, s20
  s_cselect_b32 s21, 1988493311, s21
  s_cmp_ge_u32 s5, 10
  s_cselect_b32 s20, 554696703, s20
  s_cselect_b32 s21, 4287063363, s21
  s_lshl_b32 s30, s3, 2
  s_lshr_b64 s[20:21], s[20:21], s30
  s_and_b32 s21, s20, 15
  s_cmp_ge_u32 s21, 9
  s_cbranch_scc1 L_a_wq
L_a_fetch:
  s_lshl_b32 s30, s21, 2
  s_add_u32 s30, s30, 92160
  v_mov_b32 v6, s30
  s_lshl_b32 s30, s21, 9
  s_lshr_b32 s26, s21, 2
  s_mul_i32 s26, s26, 640
  s_and_b32 s31, s21, 3
  s_lshl_b32 s31, s31, 7
  s_add_u32 s31, s26, s31
  s_add_u32 s31, s31, 90112
  s_cmp_eq_u32 s3, 13
  s_cselect_b32 s30, 34304, s30
  s_cselect_b32 s31, 91392, s31
  s_and_b32 s26, s4, 7
  s_lshl_b32 s26, s26, 12
  s_add_u32 s26, s26, s30
  s_and_b32 s30, s4, 8
  s_lshl3_add_u32 s26, s30, s26
  s_add_u32 s26, s26, 589824
  s_add_u32 s28, s16, s26
  s_addc_u32 s29, s17, 0
  v_lshlrev_b32 v8, 2, v1
  v_add_u32 v8, s31, v8
  v_mov_b32 v124, 0
  s_mov_b32 s31, 524288
  s_waitcnt lgkmcnt(0)
  s_mul_i32 s96, s97, 0x9E3779B1
  s_add_u32 s96, s96, 0x7F4A7C15
  v_mov_b32 v125, s96
  s_cmp_ge_u32 s5, 10
  s_cbranch_scc1 L_kq_poll
  v_mov_b32 v14, 92196
  s_mov_b32 s30, 4194304
L_gate:
  s_sleep 2
  ds_read_b32 v15, v14
  s_sub_u32 s30, s30, 1
  s_cbranch_scc1 L_kq_poll
  s_waitcnt lgkmcnt(0)
  v_cmp_ne_u32 vcc, 1, v15
  s_cbranch_vccnz L_gate
L_kq_poll:
  s_load_dwordx16 s[32:47], s[28:29], 0 glc
  s_load_dwordx16 s[48:63], s[28:29], 128 glc
  s_load_dwordx16 s[64:79], s[28:29], 256 glc
  s_load_dwordx16 s[80:95], s[28:29], 384 glc
  s_sub_u32 s31, s31, 1
  s_cbranch_scc1 L_kq_go
  s_waitcnt lgkmcnt(0)
  s_cmp_lg_u32 s47, s96
  s_cbranch_scc1 L_kq_poll
  s_cmp_lg_u32 s63, s96
  s_cbranch_scc1 L_kq_poll
  s_cmp_lg_u32 s79, s96
  s_cbranch_scc1 L_kq_poll
  s_cmp_lg_u32 s95, s96
  s_cbranch_scc1 L_kq_poll
L_kq_go:
  s_waitcnt lgkmcnt(0)
  v_writelane_b32 v124, s32, 0
  v_writelane_b32 v125, s33, 0
  v_writelane_b32 v124, s34, 1
  v_writelane_b32 v125, s35, 1
  v_writelane_b32 v124, s36, 2
  v_writelane_b32 v125, s37, 2
  v_writelane_b32 v124, s38, 3
  v_writelane_b32 v125, s39, 3
  v_writelane_b32 v124, s40, 4
  v_writelane_b32 v125, s41, 4
  v_writelane_b32 v124, s42, 5
  v_writelane_b32 v125, s43, 5
  v_writelane_b32 v124, s44, 6
  v_writelane_b32 v125, s45, 6
  v_writelane_b32 v124, s46, 7
  v_writelane_b32 v125, s47, 7
  v_writelane_b32 v124, s48, 8
  v_writelane_b32 v125, s49, 8
  v_writelane_b32 v124, s50, 9
  v_writelane_b32 v125, s51, 9
  v_writelane_b32 v124, s52, 10
  v_writelane_b32 v125, s53, 10
  v_writelane_b32 v124, s54, 11
  v_writelane_b32 v125, s55, 11
  v_writelane_b32 v124, s56, 12
  v_writelane_b32 v125, s57, 12
  v_writelane_b32 v124, s58, 13
  v_writelane_b32 v125, s59, 13
  v_writelane_b32 v124, s60, 14
  v_writelane_b32 v125, s61, 14
  v_writelane_b32 v124, s62, 15
  v_writelane_b32 v125, s63, 15
  v_writelane_b32 v124, s64, 16
  v_writelane_b32 v125, s65, 16
  v_writelane_b32 v124, s66, 17
  v_writelane_b32 v125, s67, 17
  v_writelane_b32 v124, s68, 18
  v_writelane_b32 v125, s69, 18
  v_writelane_b32 v124, s70, 19
  v_writelane_b32 v125, s71, 19
  v_writelane_b32 v124, s72, 20
  v_writelane_b32 v125, s73, 20
  v_writelane_b32 v124, s74, 21
  v_writelane_b32 v125, s75, 21
  v_writelane_b32 v124, s76, 22
  v_writelane_b32 v125, s77, 22
  v_writelane_b32 v124, s78, 23
  v_writelane_b32 v125, s79, 23
  v_writelane_b32 v124, s80, 24
  v_writelane_b32 v125, s81, 24
  v_writelane_b32 v124, s82, 25
  v_writelane_b32 v125, s83, 25
  v_writelane_b32 v124, s84, 26
  v_writelane_b32 v125, s85, 26
  v_writelane_b32 v124, s86, 27
  v_writelane_b32 v125, s87, 27
  v_writelane_b32 v124, s88, 28
  v_writelane_b32 v125, s89, 28
  v_writelane_b32 v124, s90, 29
  v_writelane_b32 v125, s91, 29
  v_writelane_b32 v124, s92, 30
  v_writelane_b32 v125, s93, 30
  v_writelane_b32 v124, s94, 31
  v_writelane_b32 v125, s95, 31
  v_cmp_ne_u32 vcc, s96, v125
  s_cmp_le_i32 s31, 0
  s_cbranch_scc1 L_kq_ok
  s_cbranch_vccnz L_kq_poll
L_kq_ok:
  s_cmp_eq_u32 s3, 13
  s_cselect_b32 exec_hi, -1, 0
  ds_write_b32 v8, v124
  s_mov_b64 exec, 1
  v_mov_b32 v125, 1
  ds_write_b32 v6, v125
  s_mov_b64 exec, -1
  s_cmp_lt_u32 s3, s25
  s_cbranch_scc1 L_a_wq
  s_cmp_eq_u32 s3, 9
  s_cbranch_scc1 L_a_sig0
  s_cmp_eq_u32 s3, 12
  s_cbranch_scc1 L_a_sig0
  s_branch L_a_idle
L_a_wq:
  s_mov_b32 s30, 4194304
  s_branch L_kq_fw1
L_kq_fw:
  s_sleep 1
L_kq_fw1:
  ds_read_b32 v124, v7
  s_sub_u32 s30, s30, 1
  s_cbranch_scc1 L_kq_fw_x
  s_waitcnt lgkmcnt(0)
  v_cmp_ne_u32 vcc, 1, v124
  s_cbranch_vccnz L_kq_fw
L_kq_fw_x:
  ds_read_b128 v[80:83], v9 offset:0
  ds_read_b128 v[84:87], v9 offset:128
  ds_read_b128 v[88:91], v9 offset:256
  ds_read_b128 v[92:95], v9 offset:384
  ds_read_b128 v[104:107], v10
  s_waitcnt vmcnt(8)
  s_waitcnt lgkmcnt(4)
  v_mfma_f32_16x16x32_bf16 v[96:99], v[16:19], v[80:83], 0
  v_mfma_f32_16x16x32_bf16 v[100:103], v[32:35], v[80:83], 0
  s_waitcnt lgkmcnt(3)
  v_mfma_f32_16x16x32_bf16 v[96:99], v[20:23], v[84:87], v[96:99]
  v_mfma_f32_16x16x32_bf16 v[100:103], v[36:39], v[84:87], v[100:103]
  s_waitcnt lgkmcnt(2)
  v_mfma_f32_16x16x32_bf16 v[96:99], v[24:27], v[88:91], v[96:99]
  v_mfma_f32_16x16x32_bf16 v[100:103], v[40:43], v[88:91], v[100:103]
  s_waitcnt lgkmcnt(1)
  v_mfma_f32_16x16x32_bf16 v[96:99], v[28:31], v[92:95], v[96:99]
  v_mfma_f32_16x16x32_bf16 v[100:103], v[44:47], v[92:95], v[100:103]
  s_waitcnt lgkmcnt(0)
  v_mfma_f32_16x16x32_bf16 v[96:99], v[28:31], v[104:107], v[96:99]
  v_mfma_f32_16x16x32_bf16 v[100:103], v[44:47], v[104:107], v[100:103]
  s_nop 6
  v_add_f32_dpp v104, v97, v96 row_shl:4 row_mask:0xf bank_mask:0x5
  v_add_f32_dpp v105, v99, v98 row_shl:4 row_mask:0xf bank_mask:0x5
  v_add_f32_dpp v106, v101, v100 row_shl:4 row_mask:0xf bank_mask:0x5
  v_add_f32_dpp v107, v103, v102 row_shl:4 row_mask:0xf bank_mask:0x5
  v_add_f32_dpp v104, v96, v97 row_shr:4 row_mask:0xf bank_mask:0xa
  v_add_f32_dpp v105, v98, v99 row_shr:4 row_mask:0xf bank_mask:0xa
  v_add_f32_dpp v106, v100, v101 row_shr:4 row_mask:0xf bank_mask:0xa
  v_add_f32_dpp v107, v102, v103 row_shr:4 row_mask:0xf bank_mask:0xa
  v_max3_f32 v108, v104, v105, v106
  v_max_f32 v108, v108, v107
  v_mov_b32 v109, v108
  s_nop 1
  v_permlane32_swap_b32 v109, v108
  v_max_f32 v108, v108, v109
  v_mov_b32 v109, v108
  s_nop 1
  v_permlane16_swap_b32 v109, v108
  v_max_f32 v108, v108, v109
  v_mul_f32 v108, s27, v108
  v_fma_f32 v104, v104, s27, -v108
  v_fma_f32 v105, v105, s27, -v108
  v_fma_f32 v106, v106, s27, -v108
  v_fma_f32 v107, v107, s27, -v108
  v_exp_f32 v104, v104
  v_exp_f32 v105, v105
  v_exp_f32 v106, v106
  v_exp_f32 v107, v107
  v_add_f32 v109, v104, v105
  v_add_f32 v110, v106, v107
  v_cvt_pk_bf16_f32 v104, v104, v104
  v_cvt_pk_bf16_f32 v105, v105, v105
  v_cvt_pk_bf16_f32 v106, v106, v106
  v_cvt_pk_bf16_f32 v107, v107, v107
  v_add_f32 v109, v109, v110
  v_mov_b32 v110, v109
  s_nop 1
  v_permlane32_swap_b32 v110, v109
  v_add_f32 v109, v109, v110
  v_mov_b32 v110, v109
  s_nop 1
  v_permlane16_swap_b32 v110, v109
  v_add_f32 v109, v109, v110
  v_mov_b32 v110, 1
  s_mov_b64 exec, 0x101
  ds_write_b96 v12, v[108:110]
  s_mov_b64 exec, -1
  v_and_b32 v16, v104, v120
  v_and_b32 v17, v104, v121
  v_and_b32 v18, v104, v122
  v_and_b32 v19, v104, v123
  s_waitcnt vmcnt(6)
  s_nop 0
  v_mfma_f32_16x16x32_bf16 v[112:115], v[16:19], v[48:51], 0
  v_mfma_f32_16x16x32_bf16 v[116:119], v[16:19], v[52:55], 0
  v_and_b32 v20, v105, v120
  v_and_b32 v21, v105, v121
  v_and_b32 v22, v105, v122
  v_and_b32 v23, v105, v123
  s_waitcnt vmcnt(4)
  s_nop 0
  v_mfma_f32_16x16x32_bf16 v[112:115], v[20:23], v[56:59], v[112:115]
  v_mfma_f32_16x16x32_bf16 v[116:119], v[20:23], v[60:63], v[116:119]
  v_and_b32 v24, v106, v120
  v_and_b32 v25, v106, v121
  v_and_b32 v26, v106, v122
  v_and_b32 v27, v106, v123
  s_waitcnt vmcnt(2)
  s_nop 0
  v_mfma_f32_16x16x32_bf16 v[112:115], v[24:27], v[64:67], v[112:115]
  v_mfma_f32_16x16x32_bf16 v[116:119], v[24:27], v[68:71], v[116:119]
  v_and_b32 v28, v107, v120
  v_and_b32 v29, v107, v121
  v_and_b32 v30, v107, v122
  v_and_b32 v31, v107, v123
  s_waitcnt vmcnt(0)
  s_nop 0
  v_mfma_f32_16x16x32_bf16 v[112:115], v[28:31], v[72:75], v[112:115]
  v_mfma_f32_16x16x32_bf16 v[116:119], v[28:31], v[76:79], v[116:119]
  s_nop 6
  ds_write_b128 v4, v[112:115]
  ds_write_b128 v4, v[116:119] offset:1024
  s_cmp_lt_u32 s3, 4
  s_cbranch_scc1 L_a_comb
L_a_bar:
  s_waitcnt lgkmcnt(0)
  s_barrier
  s_branch L_a_done
L_a_free:
  s_load_dword s97, s[56:57], 0
  s_mov_b32 s16, s56
  s_mov_b32 s17, s57
  s_cmp_ge_u32 s3, 12
  s_cbranch_scc1 L_a_free1
  s_lshl_b32 s30, s3, 11
  s_add_u32 s30, s30, 65536
  v_lshlrev_b32 v4, 4, v1
  v_add_u32 v4, s30, v4
  v_mov_b32 v16, 0
  v_mov_b32 v17, 0
  v_mov_b32 v18, 0
  v_mov_b32 v19, 0
  ds_write_b128 v4, v[16:19]
  ds_write_b128 v4, v[16:19] offset:1024
  v_mov_b32 v20, 0xff7fffff
  v_mov_b32 v21, 0
  v_mov_b32 v22, 1
  v_subrev_u32 v12, 8, v12
  s_mov_b64 exec, 3
  ds_write_b96 v12, v[20:22]
  s_mov_b64 exec, -1
L_a_free1:
  s_mov_b32 s20, 4283707920
  s_mov_b32 s21, 4287102831
  s_cmp_ge_u32 s5, 4
  s_cselect_b32 s20, 4294193680, s20
  s_cselect_b32 s21, 1988493311, s21
  s_cmp_ge_u32 s5, 10
  s_cselect_b32 s20, 554696703, s20
  s_cselect_b32 s21, 4287063363, s21
  s_lshl_b32 s30, s3, 2
  s_lshr_b64 s[20:21], s[20:21], s30
  s_and_b32 s21, s20, 15
  s_cmp_lt_u32 s21, 9
  s_cbranch_scc1 L_a_fetch
L_a_free1b:
  s_cmp_ge_u32 s24, 56
  s_cbranch_scc1 L_a_idle
  s_and_b32 s30, s2, 7
  s_xor_b32 s30, s30, 7
  s_lshr_b32 s26, s2, 3
  s_lshl3_add_u32 s30, s30, s26
  s_mul_i32 s26, s30, 37
  s_lshr_b32 s26, s26, 8
  s_mul_i32 s27, s26, 7
  s_sub_u32 s27, s30, s27
  s_bitcmp1_b32 s3, 1
  s_cbranch_scc1 L_a_free2
  s_branch L_a_idle
L_a_sig0:
  s_cmp_ge_u32 s24, 56
  s_cbranch_scc1 L_a_idle
  s_and_b32 s30, s2, 7
  s_xor_b32 s30, s30, 7
  s_lshr_b32 s26, s2, 3
  s_lshl3_add_u32 s30, s30, s26
  s_mul_i32 s26, s30, 37
  s_lshr_b32 s26, s26, 8
  s_mul_i32 s27, s26, 7
  s_sub_u32 s27, s30, s27
  s_lshl_b32 s62, s26, 6
  s_add_u32 s62, s62, 32256
  s_add_u32 s72, s16, s62
  s_addc_u32 s73, s17, 0
  s_mov_b32 s62, 524288
  s_mov_b32 s22, 524288
  s_cmp_eq_u32 s3, 9
  s_cbranch_scc1 L_wo_x
L_wo_pf:
  s_load_dwordx16 s[76:91], s[72:73], 0 glc
  s_sub_u32 s62, s62, 1
  s_cbranch_scc1 L_a_bar
  s_waitcnt lgkmcnt(0)
  s_cmp_lg_u32 s77, s96
  s_cbranch_scc1 L_wo_pf
  s_cmp_lg_u32 s79, s96
  s_cbranch_scc1 L_wo_pf
  s_cmp_lg_u32 s81, s96
  s_cbranch_scc1 L_wo_pf
  s_cmp_lg_u32 s83, s96
  s_cbranch_scc1 L_wo_pf
  s_cmp_lg_u32 s85, s96
  s_cbranch_scc1 L_wo_pf
  s_cmp_lg_u32 s87, s96
  s_cbranch_scc1 L_wo_pf
  s_cmp_lg_u32 s89, s96
  s_cbranch_scc1 L_wo_pf
  s_cmp_lg_u32 s91, s96
  s_cbranch_scc1 L_wo_pf
  s_branch L_a_bar
L_wo_x:
  s_load_dwordx16 s[32:47], s[16:17], 28672 glc
  s_load_dwordx16 s[48:63], s[16:17], 28736 glc
  s_load_dwordx16 s[64:79], s[16:17], 28800 glc
  s_load_dwordx16 s[80:95], s[16:17], 28864 glc
  s_sub_u32 s22, s22, 1
  s_cbranch_scc1 L_a_bar
  s_waitcnt lgkmcnt(0)
  s_cmp_lg_u32 s33, s96
  s_cbranch_scc1 L_wo_x
  s_cmp_lg_u32 s35, s96
  s_cbranch_scc1 L_wo_x
  s_cmp_lg_u32 s37, s96
  s_cbranch_scc1 L_wo_x
  s_cmp_lg_u32 s39, s96
  s_cbranch_scc1 L_wo_x
  s_cmp_lg_u32 s41, s96
  s_cbranch_scc1 L_wo_x
  s_cmp_lg_u32 s43, s96
  s_cbranch_scc1 L_wo_x
  s_cmp_lg_u32 s45, s96
  s_cbranch_scc1 L_wo_x
  s_cmp_lg_u32 s47, s96
  s_cbranch_scc1 L_wo_x
  s_cmp_lg_u32 s49, s96
  s_cbranch_scc1 L_wo_x
  s_cmp_lg_u32 s51, s96
  s_cbranch_scc1 L_wo_x
  s_cmp_lg_u32 s53, s96
  s_cbranch_scc1 L_wo_x
  s_cmp_lg_u32 s55, s96
  s_cbranch_scc1 L_wo_x
  s_cmp_lg_u32 s57, s96
  s_cbranch_scc1 L_wo_x
  s_cmp_lg_u32 s59, s96
  s_cbranch_scc1 L_wo_x
  s_cmp_lg_u32 s61, s96
  s_cbranch_scc1 L_wo_x
  s_cmp_lg_u32 s63, s96
  s_cbranch_scc1 L_wo_x
  s_cmp_lg_u32 s65, s96
  s_cbranch_scc1 L_wo_x
  s_cmp_lg_u32 s67, s96
  s_cbranch_scc1 L_wo_x
  s_cmp_lg_u32 s69, s96
  s_cbranch_scc1 L_wo_x
  s_cmp_lg_u32 s71, s96
  s_cbranch_scc1 L_wo_x
  s_cmp_lg_u32 s73, s96
  s_cbranch_scc1 L_wo_x
  s_cmp_lg_u32 s75, s96
  s_cbranch_scc1 L_wo_x
  s_cmp_lg_u32 s77, s96
  s_cbranch_scc1 L_wo_x
  s_cmp_lg_u32 s79, s96
  s_cbranch_scc1 L_wo_x
  s_cmp_lg_u32 s81, s96
  s_cbranch_scc1 L_wo_x
  s_cmp_lg_u32 s83, s96
  s_cbranch_scc1 L_wo_x
  s_cmp_lg_u32 s85, s96
  s_cbranch_scc1 L_wo_x
  s_cmp_lg_u32 s87, s96
  s_cbranch_scc1 L_wo_x
  s_branch L_a_bar
L_a_free2:
  v_lshrrev_b32 v8, 3, v1
  v_and_b32 v7, 7, v1
  v_and_b32 v14, 1, v3
  v_lshlrev_b32 v14, 1, v14
  v_xor_b32 v7, v7, v14
  v_lshlrev_b32 v7, 4, v7
  s_mov_b32 s20, s40
  s_mov_b32 s21, s41
  s_mov_b32 s22, 3670016
  s_mov_b32 s23, 0x20000
  s_and_b32 s31, s3, 1
  s_bfe_u32 s30, s3, 0x10002
  s_lshl1_add_u32 s31, s30, s31
  s_lshl2_add_u32 s60, s26, s31
  s_mul_i32 s60, s60, 114688
  s_lshl_b32 s30, s27, 7
  s_add_u32 s60, s60, s30
  s_lshl_b32 s31, s31, 14
  v_mul_u32_u24 v10, 896, v8
  v_add_u32 v14, v7, v10
  v_xor_b32 v15, 64, v7
  v_add_u32 v15, v15, v10
  s_mov_b32 m0, s31
  s_mov_b32 s30, 8
L_do_wo:
  buffer_load_dwordx4 v14, s[20:23], s60 offen nt lds
  s_add_u32 s60, s60, 7168
  s_add_u32 m0, m0, 1024
  s_sub_u32 s30, s30, 1
  buffer_load_dwordx4 v15, s[20:23], s60 offen nt lds
  s_add_u32 s60, s60, 7168
  s_add_u32 m0, m0, 1024
  s_cmp_lg_u32 s30, 0
  s_cbranch_scc1 L_do_wo
  s_waitcnt lgkmcnt(0)
  s_barrier
  v_mov_b32 v13, 1
  s_waitcnt vmcnt(0)
  s_mov_b64 exec, 1
  ds_write_b32 v6, v13
  s_mov_b64 exec, -1
  s_branch L_a_done
L_a_idle:
  s_cmp_lt_u32 s24, 56
  s_cbranch_scc1 L_a_bar
  s_waitcnt lgkmcnt(0)
  s_branch L_fin
L_a_comb:
  v_bfe_u32 v14, v0, 6, 1
  v_lshlrev_b32 v14, 8, v14
  v_min_u32 v11, 11, v2
  v_lshl_add_u32 v11, v11, 4, v14
  v_add_u32 v11, 91648, v11
  v_cmp_gt_u32 s[20:21], 12, v2
  v_and_b32 v15, 128, v0
  v_lshl_add_u32 v9, v15, 3, v14
  v_add_u32 v9, v9, v14
  v_add_u32 v14, v14, v15
  v_lshl_add_u32 v14, v1, 1, v14
  v_lshrrev_b32 v15, 6, v14
  v_mul_u32_u24 v15, 3584, v15
  v_and_b32 v14, 63, v14
  v_lshl_add_u32 v8, v14, 1, v15
  v_bfe_u32 v15, v1, 1, 1
  v_lshl_add_u32 v9, v15, 8, v9
  v_lshlrev_b32 v14, 2, v15
  v_lshrrev_b32 v15, 2, v1
  v_xor_b32 v15, v15, v14
  v_lshl_add_u32 v9, v15, 4, v9
  v_and_b32 v15, 1, v1
  v_lshl_add_u32 v9, v15, 3, v9
  v_add_u32 v9, 65536, v9
  s_and_b32 s28, s4, 7
  s_lshr_b32 s29, s4, 3
  s_mul_i32 s29, s29, 14
  s_add_u32 s29, s29, s5
  s_lshl_b32 s29, s29, 7
  s_lshl_b32 s28, s28, 15
  s_add_u32 s28, s28, s29
  s_add_u32 s28, s28, 65536
  s_lshl2_add_u32 s29, s3, s28
  s_add_u32 s29, s29, 28672
  v_mov_b32 v13, 0
  s_mov_b32 s30, 4194304
L_ml_fw:
  ds_read_b96 v[80:82], v11
  s_sub_u32 s30, s30, 1
  s_cbranch_scc1 L_ml_fw_x
  s_waitcnt lgkmcnt(0)
  v_cmp_ne_u32 vcc, 1, v82
  s_cbranch_vccnz L_ml_fw
L_ml_fw_x:
  v_mov_b32 v83, v80
  s_nop 1
  v_max_f32_dpp v83, v83, v83 row_ror:1 row_mask:0xf bank_mask:0xf
  s_nop 1
  v_max_f32_dpp v83, v83, v83 row_ror:2 row_mask:0xf bank_mask:0xf
  s_nop 1
  v_max_f32_dpp v83, v83, v83 row_ror:4 row_mask:0xf bank_mask:0xf
  s_nop 1
  v_max_f32_dpp v83, v83, v83 row_ror:8 row_mask:0xf bank_mask:0xf
  v_sub_f32 v80, v80, v83
  v_exp_f32 v80, v80
  s_nop 0
  v_mul_f32 v81, v81, v80
  v_cndmask_b32 v81, 0, v81, s[20:21]
  s_nop 1
  v_add_f32_dpp v81, v81, v81 row_ror:1 row_mask:0xf bank_mask:0xf
  s_nop 1
  v_add_f32_dpp v81, v81, v81 row_ror:2 row_mask:0xf bank_mask:0xf
  s_nop 1
  v_add_f32_dpp v81, v81, v81 row_ror:4 row_mask:0xf bank_mask:0xf
  s_nop 1
  v_add_f32_dpp v81, v81, v81 row_ror:8 row_mask:0xf bank_mask:0xf
  v_rcp_f32 v82, v81
  v_log_f32 v81, v81
  v_mul_f32 v80, v80, v82
  v_add_f32 v81, v81, v83
  v_min_u32 v81, -2, v81
  s_cmp_ge_u32 s3, 2
  s_cbranch_scc1 L_a_nolse
  s_mov_b64 exec, 1
  buffer_store_dword v81, v13, s[16:19], s29 offen sc1
  s_mov_b64 exec, -1
L_a_nolse:
  v_readlane_b32 s32, v80, 0
  v_readlane_b32 s34, v80, 1
  v_readlane_b32 s36, v80, 2
  v_readlane_b32 s38, v80, 3
  v_readlane_b32 s40, v80, 4
  v_readlane_b32 s42, v80, 5
  v_readlane_b32 s44, v80, 6
  v_readlane_b32 s46, v80, 7
  v_readlane_b32 s48, v80, 8
  v_readlane_b32 s50, v80, 9
  v_readlane_b32 s52, v80, 10
  v_readlane_b32 s54, v80, 11
  s_waitcnt lgkmcnt(0)
  s_barrier
  ds_read2st64_b64 v[16:19], v9 offset0:0 offset1:4
  ds_read2st64_b64 v[20:23], v9 offset0:8 offset1:12
  ds_read2st64_b64 v[24:27], v9 offset0:16 offset1:20
  ds_read2st64_b64 v[28:31], v9 offset0:24 offset1:28
  ds_read2st64_b64 v[32:35], v9 offset0:32 offset1:36
  ds_read2st64_b64 v[36:39], v9 offset0:40 offset1:44
  s_waitcnt lgkmcnt(5)
  v_pk_mul_f32 v[80:81], v[16:17], s[32:33] op_sel_hi:[1,0]
  v_pk_mul_f32 v[82:83], v[18:19], s[34:35] op_sel_hi:[1,0]
  s_waitcnt lgkmcnt(4)
  v_pk_fma_f32 v[80:81], v[20:21], s[36:37], v[80:81] op_sel_hi:[1,0,1]
  v_pk_fma_f32 v[82:83], v[22:23], s[38:39], v[82:83] op_sel_hi:[1,0,1]
  s_waitcnt lgkmcnt(3)
  v_pk_fma_f32 v[80:81], v[24:25], s[40:41], v[80:81] op_sel_hi:[1,0,1]
  v_pk_fma_f32 v[82:83], v[26:27], s[42:43], v[82:83] op_sel_hi:[1,0,1]
  s_waitcnt lgkmcnt(2)
  v_pk_fma_f32 v[80:81], v[28:29], s[44:45], v[80:81] op_sel_hi:[1,0,1]
  v_pk_fma_f32 v[82:83], v[30:31], s[46:47], v[82:83] op_sel_hi:[1,0,1]
  s_waitcnt lgkmcnt(1)
  v_pk_fma_f32 v[80:81], v[32:33], s[48:49], v[80:81] op_sel_hi:[1,0,1]
  v_pk_fma_f32 v[82:83], v[34:35], s[50:51], v[82:83] op_sel_hi:[1,0,1]
  s_waitcnt lgkmcnt(0)
  v_pk_fma_f32 v[80:81], v[36:37], s[52:53], v[80:81] op_sel_hi:[1,0,1]
  v_pk_fma_f32 v[82:83], v[38:39], s[54:55], v[82:83] op_sel_hi:[1,0,1]
  v_pk_add_f32 v[80:81], v[80:81], v[82:83]
  v_cvt_pk_bf16_f32 v16, v80, v81
  v_min_u32 v16, -2, v16
  s_nop 1
  v_mov_b32_dpp v17, v16 quad_perm:[1,1,1,1] row_mask:0xf bank_mask:0xf
  v_mov_b32_dpp v18, v16 quad_perm:[2,2,2,2] row_mask:0xf bank_mask:0xf
  v_mov_b32_dpp v19, v16 quad_perm:[3,3,3,3] row_mask:0xf bank_mask:0xf
  s_mov_b32 exec_lo, 0x11111111
  s_mov_b32 exec_hi, 0x11111111
  buffer_store_dwordx4 v[16:19], v8, s[16:19], s28 offen sc1
  s_mov_b64 exec, -1
L_a_done:
  s_cmp_ge_u32 s24, 56
  s_cbranch_scc1 L_fin
  s_and_b32 s30, s2, 7
  s_xor_b32 s30, s30, 7
  s_lshr_b32 s4, s2, 3
  s_lshl3_add_u32 s30, s30, s4
  s_mul_i32 s4, s30, 37
  s_lshr_b32 s4, s4, 8
  s_mul_i32 s5, s4, 7
  s_sub_u32 s5, s30, s5
  v_and_b32 v14, 1, v3
  v_lshlrev_b32 v14, 1, v14
  v_lshrrev_b32 v15, 2, v2
  v_lshl_add_u32 v9, v3, 3, v15
  v_lshlrev_b32 v9, 7, v9
  v_lshrrev_b32 v15, 1, v15
  v_or_b32 v15, v15, v14
  v_lshl_add_u32 v9, v15, 5, v9
  v_and_b32 v15, 3, v2
  v_lshl_add_u32 v9, v15, 3, v9
  s_and_b32 s6, s3, 7
  s_lshr_b32 s7, s3, 3
  v_min_u32 v10, 13, v2
  v_lshlrev_b32 v10, 7, v10
  v_lshl_add_u32 v10, v3, 4, v10
  s_lshl_b32 s31, s4, 15
  s_mul_i32 s62, s7, 1792
  s_add_u32 s31, s31, s62
  s_add_u32 s31, s31, 65536
  s_mul_i32 s30, s6, 3584
  s_add_u32 s30, s30, s31
  s_lshr_b32 s62, s6, 2
  s_lshl2_add_u32 s31, s62, s31
  s_add_u32 s31, s31, 28672
  v_min_u32 v88, 13, v2
  v_lshlrev_b32 v88, 7, v88
  v_cmp_gt_u32 s[64:65], 14, v2
  s_lshr_b32 s62, s3, 2
  s_lshl_b32 s62, s62, 6
  s_add_u32 s62, s62, 133888
  v_lshlrev_b32 v89, 2, v2
  v_add_u32 v89, s62, v89
  v_lshlrev_b32 v90, 4, v3
  v_add_u32 v90, s62, v90
  v_mov_b32 v56, -1
  s_mov_b64 s[66:67], -1
  s_and_b32 s62, s3, 3
  s_cmp_eq_u32 s62, 0
  s_cselect_b64 s[68:69], 0xffff, 0
  s_cselect_b32 s70, 1, 0
  s_lshl_b32 s62, s6, 13
  v_add_u32 v12, s62, v9
  v_xor_b32 v13, 32, v12
  v_xor_b32 v14, 64, v12
  v_xor_b32 v15, 0x60, v12
  v_lshlrev_b32 v4, 2, v0
  v_add_u32 v4, 129792, v4
  v_lshlrev_b32 v7, 2, v1
  s_lshl_b32 s62, s3, 11
  s_add_u32 s62, s62, 129792
  v_add_u32 v5, s62, v7
  s_lshl3_add_u32 s28, s3, s4
  s_mul_i32 s28, s28, 1792
  s_lshl_b32 s29, s5, 8
  s_add_u32 s28, s28, s29
  s_add_u32 s28, s28, 327680
  v_mov_b32 v92, 0xff7fffff
  v_and_b32 v91, 1, v1
  v_and_b32 v93, 2, v1
  v_lshlrev_b32 v91, 2, v91
  v_lshl_add_u32 v91, v93, 3, v91
  v_add_u32 v91, 92200, v91
  s_mov_b32 s71, 1
L_wo_nox:
  s_mov_b32 s62, 524288
  s_waitcnt lgkmcnt(0)
L_wo_poll:
  s_mov_b64 exec, s[66:67]
  s_cbranch_execz L_wo_p0
  buffer_load_dwordx4 v[48:51], v10, s[16:19], s30 offen sc1
  buffer_load_dwordx4 v[52:55], v10, s[16:19], s30 offen offset:64 sc1
L_wo_p0:
  s_cmp_eq_u32 s71, 0
  s_cbranch_scc1 L_wo_p1
  s_mov_b64 exec, -1
  ds_read_b32 v93, v91
  s_waitcnt lgkmcnt(0)
  v_cmp_ne_u32 vcc, 1, v93
  s_cbranch_vccnz L_wo_p1
  ds_read_b64_tr_b16 v[16:17], v12 offset:0
  ds_read_b64_tr_b16 v[18:19], v12 offset:512
  ds_read_b64_tr_b16 v[20:21], v13 offset:0
  ds_read_b64_tr_b16 v[22:23], v13 offset:512
  ds_read_b64_tr_b16 v[24:25], v14 offset:0
  ds_read_b64_tr_b16 v[26:27], v14 offset:512
  ds_read_b64_tr_b16 v[28:29], v15 offset:0
  ds_read_b64_tr_b16 v[30:31], v15 offset:512
  ds_read_b64_tr_b16 v[32:33], v12 offset:4096
  ds_read_b64_tr_b16 v[34:35], v12 offset:4608
  ds_read_b64_tr_b16 v[36:37], v13 offset:4096
  ds_read_b64_tr_b16 v[38:39], v13 offset:4608
  ds_read_b64_tr_b16 v[40:41], v14 offset:4096
  ds_read_b64_tr_b16 v[42:43], v14 offset:4608
  ds_read_b64_tr_b16 v[44:45], v15 offset:4096
  ds_read_b64_tr_b16 v[46:47], v15 offset:4608
  s_mov_b32 s71, 0
L_wo_p1:
  s_cmp_eq_u32 s70, 0
  s_cbranch_scc1 L_wo_p2
  s_mov_b64 exec, s[68:69]
  buffer_load_dword v56, v88, s[16:19], s31 offen sc1
  s_waitcnt vmcnt(0)
  v_cmp_eq_u32 s[68:69], -1, v56
  s_cmp_lg_u64 s[68:69], 0
  s_cbranch_scc1 L_wo_p2
L_wo_w:
  s_mov_b64 exec, 0xffff
  v_mov_b32 v57, v56
  s_nop 1
  v_max_f32_dpp v57, v57, v57 row_ror:1 row_mask:0xf bank_mask:0xf
  s_nop 1
  v_max_f32_dpp v57, v57, v57 row_ror:2 row_mask:0xf bank_mask:0xf
  s_nop 1
  v_max_f32_dpp v57, v57, v57 row_ror:4 row_mask:0xf bank_mask:0xf
  s_nop 1
  v_max_f32_dpp v57, v57, v57 row_ror:8 row_mask:0xf bank_mask:0xf
  v_cndmask_b32 v56, v92, v56, s[64:65]
  v_sub_f32 v56, v56, v57
  v_exp_f32 v56, v56
  s_nop 0
  v_mov_b32 v57, v56
  s_nop 1
  v_add_f32_dpp v57, v57, v57 row_ror:1 row_mask:0xf bank_mask:0xf
  s_nop 1
  v_add_f32_dpp v57, v57, v57 row_ror:2 row_mask:0xf bank_mask:0xf
  s_nop 1
  v_add_f32_dpp v57, v57, v57 row_ror:4 row_mask:0xf bank_mask:0xf
  s_nop 1
  v_add_f32_dpp v57, v57, v57 row_ror:8 row_mask:0xf bank_mask:0xf
  v_rcp_f32 v57, v57
  s_nop 0
  v_mul_f32 v56, v56, v57
  v_min_u32 v56, -2, v56
  ds_write_b32 v89, v56
  s_mov_b32 s70, 0
L_wo_p2:
  s_mov_b64 exec, s[66:67]
  s_waitcnt vmcnt(0)
  v_max3_u32 v60, v48, v49, v50
  v_max3_u32 v61, v51, v52, v53
  v_max3_u32 v60, v60, v54, v55
  v_max_u32 v60, v60, v61
  v_cmp_eq_u32 s[66:67], -1, v60
  s_sub_u32 s62, s62, 1
  s_cbranch_scc1 L_wo_to
  s_or_b32 s63, s66, s67
  s_or_b32 s63, s63, s70
  s_or_b32 s63, s63, s71
  s_cbranch_scc1 L_wo_poll
  s_branch L_wo_got
L_wo_to:
  s_mov_b32 s62, 0
  s_cmp_lg_u32 s70, 0
  s_cbranch_scc1 L_wo_w
L_wo_got:
  s_mov_b64 exec, -1
  s_waitcnt lgkmcnt(0)
  ds_read_b128 v[84:87], v90
  v_mfma_f32_16x16x32_bf16 v[64:67], v[48:51], v[16:19], 0
  v_mfma_f32_16x16x32_bf16 v[64:67], v[52:55], v[32:35], v[64:67]
  v_mfma_f32_16x16x32_bf16 v[68:71], v[48:51], v[20:23], 0
  v_mfma_f32_16x16x32_bf16 v[68:71], v[52:55], v[36:39], v[68:71]
  v_mfma_f32_16x16x32_bf16 v[72:75], v[48:51], v[24:27], 0
  v_mfma_f32_16x16x32_bf16 v[72:75], v[52:55], v[40:43], v[72:75]
  v_mfma_f32_16x16x32_bf16 v[76:79], v[48:51], v[28:31], 0
  v_mfma_f32_16x16x32_bf16 v[76:79], v[52:55], v[44:47], v[76:79]
  s_mov_b32 s62, 4194304
  s_branch L_wo_wc
L_wo_wr:
  ds_read_b128 v[84:87], v90
L_wo_wc:
  s_waitcnt lgkmcnt(0)
  v_max3_u32 v60, v84, v85, v86
  v_max_u32 v60, v60, v87
  v_cmp_eq_u32 vcc, -1, v60
  s_sub_u32 s62, s62, 1
  s_cbranch_scc1 L_wo_wx
  s_cbranch_vccnz L_wo_wr
L_wo_wx:
  v_mul_f32 v80, v84, v64
  v_fmac_f32 v80, v85, v65
  v_fmac_f32 v80, v86, v66
  v_fmac_f32 v80, v87, v67
  v_mul_f32 v81, v84, v68
  v_fmac_f32 v81, v85, v69
  v_fmac_f32 v81, v86, v70
  v_fmac_f32 v81, v87, v71
  v_mul_f32 v82, v84, v72
  v_fmac_f32 v82, v85, v73
  v_fmac_f32 v82, v86, v74
  v_fmac_f32 v82, v87, v75
  v_mul_f32 v83, v84, v76
  v_fmac_f32 v83, v85, v77
  v_fmac_f32 v83, v86, v78
  v_fmac_f32 v83, v87, v79
  v_permlane32_swap_b32 v80, v82
  s_nop 0
  v_permlane32_swap_b32 v81, v83
  v_add_f32 v80, v80, v82
  v_add_f32 v81, v81, v83
  s_nop 1
  v_permlane16_swap_b32 v80, v81
  v_add_f32 v80, v80, v81
  ds_write_b32 v4, v80
  s_waitcnt lgkmcnt(0)
  s_barrier
  s_cmp_ge_u32 s3, 2
  s_cbranch_scc1 L_fin
  ds_read2st64_b32 v[16:17], v5 offset0:0 offset1:1
  ds_read2st64_b32 v[18:19], v5 offset0:2 offset1:3
  ds_read2st64_b32 v[20:21], v5 offset0:4 offset1:5
  ds_read2st64_b32 v[22:23], v5 offset0:6 offset1:7
  s_waitcnt lgkmcnt(2)
  v_add_f32 v16, v16, v17
  v_add_f32 v18, v18, v19
  s_waitcnt lgkmcnt(0)
  v_add_f32 v20, v20, v21
  v_add_f32 v22, v22, v23
  v_add_f32 v16, v16, v18
  v_add_f32 v20, v20, v22
  v_add_f32 v16, v16, v20
  v_min_u32 v16, -2, v16
  s_nop 1
  v_mov_b32_dpp v17, v16 quad_perm:[1,1,1,1] row_mask:0xf bank_mask:0xf
  v_mov_b32_dpp v18, v16 quad_perm:[2,2,2,2] row_mask:0xf bank_mask:0xf
  v_mov_b32_dpp v19, v16 quad_perm:[3,3,3,3] row_mask:0xf bank_mask:0xf
  s_mov_b32 exec_lo, 0x11111111
  s_mov_b32 exec_hi, 0x11111111
  buffer_store_dwordx4 v[16:19], v7, s[16:19], s28 offen sc1
  s_mov_b64 exec, -1
  s_branch L_fin
L_m_cont:
  s_load_dword s97, s[56:57], 0
  s_mov_b32 s16, s56
  s_mov_b32 s17, s57
  v_and_b32 v14, 1, v3
  v_lshlrev_b32 v14, 1, v14
  v_lshrrev_b32 v15, 2, v2
  v_lshl_add_u32 v9, v3, 3, v15
  v_lshlrev_b32 v9, 7, v9
  v_lshrrev_b32 v15, 1, v15
  v_or_b32 v15, v15, v14
  v_lshl_add_u32 v9, v15, 5, v9
  v_and_b32 v15, 3, v2
  v_lshl_add_u32 v9, v15, 3, v9
  v_and_b32 v15, 1, v2
  v_mul_u32_u24 v13, 3712, v15
  v_lshl_add_u32 v13, v3, 4, v13
  v_add_u32 v13, 117472, v13
  v_lshlrev_b32 v11, 6, v2
  v_lshl_add_u32 v11, v3, 4, v11
  s_lshl_b32 s31, s61, 9
  s_mul_i32 s30, s4, 28672
  s_add_u32 s31, s31, s30
  s_lshl_b32 s30, s3, 7
  s_add_u32 s31, s31, s30
  s_add_u32 s31, s31, 4096
  s_lshl_b32 s30, s3, 5
  v_xor_b32 v10, s30, v9
  s_mul_i32 s30, s4, 448
  v_add_u32 v13, s30, v13
  s_mov_b32 s65, 7
  s_mov_b32 s7, 2
  s_sub_u32 s6, s3, 4
  s_cmp_ge_u32 s3, 7
  s_cbranch_scc1 L_m_nosilu
  v_add_u32 v25, 117472, v12
  v_add_u32 v26, 120288, v12
  v_cmp_gt_u32 vcc, 224, v0
  s_nop 1
  v_cndmask_b32 v25, v26, v25, vcc
  s_waitcnt vmcnt(2)
  v_lshlrev_b32 v16, 16, v24
  v_and_b32 v17, 0xffff0000, v24
  v_mul_f32 v18, 0xbfb8aa3b, v16
  v_mul_f32 v19, 0xbfb8aa3b, v17
  v_exp_f32 v18, v18
  v_exp_f32 v19, v19
  v_add_f32 v18, 1.0, v18
  v_add_f32 v19, 1.0, v19
  v_rcp_f32 v18, v18
  v_rcp_f32 v19, v19
  v_mul_f32 v16, v16, v18
  v_mul_f32 v17, v17, v19
  v_cvt_pk_bf16_f32 v16, v16, v17
  ds_write_b32 v25, v16
L_m_nosilu:
  s_sub_u32 s30, s6, 4
  s_cmp_ge_u32 s30, 3
  s_cbranch_scc1 L_m_ne
  s_waitcnt vmcnt(1)
  s_mov_b32 s24, s46
  s_mov_b32 s25, s47
  s_mov_b32 s26, 1605632
  s_mov_b32 s27, 0x20000
  s_mul_i32 s61, s5, 57344
  s_lshl_b32 s63, s6, 7
  s_add_u32 s61, s61, s63
  s_lshl_b32 s7, s6, 13
  s_add_u32 s7, s7, 57344
  v_mul_u32_u24 v10, 896, v8
  v_add_u32 v14, v7, v10
  v_xor_b32 v15, 64, v7
  v_add_u32 v15, v15, v10
  s_mov_b32 m0, s7
  s_mov_b32 s30, 4
L_do_w2e:
  buffer_load_dwordx4 v14, s[24:27], s61 offen nt lds
  s_add_u32 s61, s61, 7168
  s_add_u32 m0, m0, 1024
  s_sub_u32 s30, s30, 1
  buffer_load_dwordx4 v15, s[24:27], s61 offen nt lds
  s_add_u32 s61, s61, 7168
  s_add_u32 m0, m0, 1024
  s_cmp_lg_u32 s30, 0
  s_cbranch_scc1 L_do_w2e
  s_waitcnt vmcnt(8)
  s_branch L_m_ne2
L_m_ne:
  s_waitcnt vmcnt(0)
L_m_ne2:
  s_waitcnt lgkmcnt(0)
  s_mul_i32 s96, s97, 0x9E3779B1
  s_add_u32 s96, s96, 0x7F4A7C15
  s_barrier
  s_cmp_lt_u32 s3, 4
  s_cbranch_scc1 L_front_gemv
L_m_ret:
  s_barrier
  v_lshlrev_b32 v12, 4, v1
  s_cmp_lg_u32 s3, 14
  s_cbranch_scc1 L_m_nopre
  s_setprio 3
  v_mov_b32 v20, -1
  v_mov_b32 v21, -1
  v_mov_b32 v22, -1
  v_mov_b32 v23, -1
  s_mul_i32 s62, s5, 9216
  s_add_u32 s62, s62, 327680
  buffer_store_dwordx4 v[20:23], v12, s[16:19], s62 offen offset:0 sc1
  buffer_store_dwordx4 v[20:23], v12, s[16:19], s62 offen offset:1024 sc1
  buffer_store_dwordx4 v[20:23], v12, s[16:19], s62 offen offset:2048 sc1
  s_add_u32 s62, s62, 3072
  buffer_store_dwordx4 v[20:23], v12, s[16:19], s62 offen offset:0 sc1
  buffer_store_dwordx4 v[20:23], v12, s[16:19], s62 offen offset:1024 sc1
  buffer_store_dwordx4 v[20:23], v12, s[16:19], s62 offen offset:2048 sc1
  s_add_u32 s62, s62, 3072
  buffer_store_dwordx4 v[20:23], v12, s[16:19], s62 offen offset:0 sc1
  buffer_store_dwordx4 v[20:23], v12, s[16:19], s62 offen offset:1024 sc1
  buffer_store_dwordx4 v[20:23], v12, s[16:19], s62 offen offset:2048 sc1
L_m_nopre:
  s_mul_i32 s30, s4, 448
  v_subrev_u32 v13, s30, v13
  s_movk_i32 s60, 5376
  s_add_u32 s61, s5, 14
  s_lshl_b32 s31, s61, 9
  s_lshl_b32 s30, s3, 7
  s_add_u32 s31, s31, s30
  s_add_u32 s31, s31, 4096
  s_lshl_b32 s61, s61, 7
  s_and_b32 s62, s3, 1
  s_lshl_b32 s62, s62, 6
  v_xor_b32 v14, s62, v7
  v_mul_lo_u32 v15, v8, s60
  v_add_u32 v14, v14, v15
  s_lshl_b32 s62, s3, 3
  s_mul_i32 s62, s62, s60
  s_add_u32 s62, s62, s61
  s_lshl_b32 s63, s60, 7
  s_lshl_b32 s30, s3, 10
  s_add_u32 m0, s30, 0
  s_nop 0
  buffer_load_dwordx4 v14, s[20:23], s62 offen nt lds
  s_add_u32 s62, s62, s63
  s_add_u32 m0, m0, 16384
  s_nop 0
  buffer_load_dwordx4 v14, s[20:23], s62 offen nt lds
  s_add_u32 s62, s62, s63
  s_add_u32 m0, m0, 16384
  s_nop 0
  buffer_load_dwordx4 v14, s[20:23], s62 offen nt lds
  s_add_u32 s62, s62, s63
  s_add_u32 m0, m0, 16384
  s_cmp_ge_u32 s3, 8
  s_cbranch_scc1 L_dma_r
  buffer_load_dwordx4 v14, s[20:23], s62 offen nt lds
L_dma_r:
  s_barrier
  s_cmp_ge_u32 s6, 4
  s_cbranch_scc1 L_m_pre
  s_mov_b32 s24, s46
  s_mov_b32 s25, s47
  s_mov_b32 s26, 1605632
  s_mov_b32 s27, 0x20000
  s_mul_i32 s61, s5, 57344
  s_lshl_b32 s63, s6, 7
  s_add_u32 s61, s61, s63
  s_lshl_b32 s7, s6, 13
  s_add_u32 s7, s7, 57344
  v_mul_u32_u24 v10, 896, v8
  v_add_u32 v14, v7, v10
  v_xor_b32 v15, 64, v7
  v_add_u32 v15, v15, v10
  s_mov_b32 m0, s7
  s_mov_b32 s30, 4
L_do_w2:
  buffer_load_dwordx4 v14, s[24:27], s61 offen nt lds
  s_add_u32 s61, s61, 7168
  s_add_u32 m0, m0, 1024
  s_sub_u32 s30, s30, 1
  buffer_load_dwordx4 v15, s[24:27], s61 offen nt lds
  s_add_u32 s61, s61, 7168
  s_add_u32 m0, m0, 1024
  s_cmp_lg_u32 s30, 0
  s_cbranch_scc1 L_do_w2
  s_waitcnt vmcnt(8)
  s_branch L_m_r
L_m_pre:
  s_cmp_lg_u32 s3, 14
  s_cbranch_scc1 L_m_r0
  s_getreg_b32 s30, hwreg(HW_REG_XCC_ID)
  s_and_b32 s30, s30, 15
  v_mov_b32 v24, s30
  v_mov_b32 v25, s96
  s_lshl_b32 s30, s5, 3
  s_add_u32 s30, s30, 28672
  s_waitcnt vmcnt(3)
  s_mov_b64 exec, 1
  buffer_store_dwordx2 v[24:25], v12, s[16:19], s30 offen sc1
  s_mov_b64 exec, -1
  s_setprio 0
  s_waitcnt vmcnt(1)
  s_branch L_m_r
L_m_r0:
  s_waitcnt vmcnt(0)
L_m_r:
  s_barrier
  s_cmp_ge_u32 s3, 4
  s_cbranch_scc1 L_m_ret2
  s_setprio 3
  s_mov_b32 s65, 14
  s_mov_b32 s7, 3
  s_branch L_front_gemv
L_m_ret2:
  s_setprio 0
  s_barrier
  s_cmp_ge_u32 s3, 7
  s_cselect_b32 s4, 1, 0
  s_mul_i32 s30, s4, 7
  s_sub_u32 s30, s3, s30
  s_lshl_b32 s30, s30, 6
  v_lshl_add_u32 v4, v2, 2, v3
  v_add_u32 v4, s30, v4
  s_mul_i32 s30, s4, 448
  v_add_u32 v126, s30, v4
  s_mov_b32 s24, s32
  s_mov_b32 s25, s33
  s_mov_b32 s26, 1792
  s_mov_b32 s27, 0x20000
  v_lshlrev_b32 v12, 1, v126
  buffer_load_ushort v122, v12, s[24:27], 0 offen
  s_mov_b32 s20, s44
  s_mov_b32 s21, s45
  s_mov_b32 s22, 1605632
  s_mov_b32 s23, 0x20000
  s_movk_i32 s60, 3584
  s_lshl_b32 s61, s5, 7
  s_and_b32 s62, s3, 1
  s_lshl_b32 s62, s62, 6
  v_xor_b32 v14, s62, v7
  v_mul_lo_u32 v15, v8, s60
  v_add_u32 v14, v14, v15
  s_lshl_b32 s62, s3, 3
  s_mul_i32 s62, s62, s60
  s_add_u32 s62, s62, s61
  s_lshl_b32 s63, s60, 7
  s_lshl_b32 s30, s3, 10
  s_add_u32 m0, s30, 0
  s_nop 0
  buffer_load_dwordx4 v14, s[20:23], s62 offen nt lds
  s_add_u32 s62, s62, s63
  s_add_u32 m0, m0, 16384
  s_nop 0
  buffer_load_dwordx4 v14, s[20:23], s62 offen nt lds
  s_add_u32 s62, s62, s63
  s_add_u32 m0, m0, 16384
  s_nop 0
  buffer_load_dwordx4 v14, s[20:23], s62 offen nt lds
  s_add_u32 s62, s62, s63
  s_add_u32 m0, m0, 16384
  s_cmp_ge_u32 s3, 8
  s_cbranch_scc1 L_dma_w1
  buffer_load_dwordx4 v14, s[20:23], s62 offen nt lds
L_dma_w1:
  s_cmp_ge_u32 s3, 14
  s_cbranch_scc1 L_m_fw
  v_lshrrev_b32 v10, 4, v4
  v_lshlrev_b32 v10, 7, v10
  v_bfe_u32 v15, v4, 1, 3
  v_lshl_add_u32 v10, v15, 3, v10
  s_lshl_b32 s62, s4, 6
  s_add_u32 s62, s62, 11264
  s_add_u32 s63, s62, 7168
  s_mov_b32 s30, 524288
L_m_mpoll:
  buffer_load_dwordx2 v[108:109], v10, s[16:19], s62 offen sc1
  buffer_load_dwordx2 v[110:111], v10, s[16:19], s62 offen offset:3584 sc1
  buffer_load_dwordx2 v[112:113], v10, s[16:19], s63 offen sc1
  buffer_load_dwordx2 v[114:115], v10, s[16:19], s63 offen offset:3584 sc1
  s_sub_u32 s30, s30, 1
  s_cbranch_scc1 L_m_mpoll_x
  s_waitcnt vmcnt(0)
  v_cmp_ne_u32 vcc, s96, v109
  v_cmp_ne_u32 s[28:29], s96, v111
  s_or_b64 vcc, vcc, s[28:29]
  v_cmp_ne_u32 s[28:29], s96, v113
  s_or_b64 vcc, vcc, s[28:29]
  v_cmp_ne_u32 s[28:29], s96, v115
  s_or_b64 vcc, vcc, s[28:29]
  s_cbranch_vccnz L_m_mpoll
L_m_mpoll_x:
  s_waitcnt vmcnt(0)
  v_and_b32 v10, 1, v4
  v_lshlrev_b32 v10, 4, v10
  v_lshrrev_b32 v108, v10, v108
  v_lshrrev_b32 v110, v10, v110
  v_lshrrev_b32 v112, v10, v112
  v_lshrrev_b32 v114, v10, v114
  v_lshlrev_b32 v123, 16, v108
  v_lshlrev_b32 v112, 16, v112
  v_add_f32 v112, 1.0, v112
  v_cvt_pk_bf16_f32 v112, v112, v112
  v_lshlrev_b32 v114, 16, v114
  s_mul_i32 s30, s4, 3712
  s_add_u32 s30, s30, 114688
  v_lshlrev_b32 v125, 1, v4
  v_add_u32 v125, s30, v125
  ds_write_b16 v125, v112 offset:928
  ds_write_b16 v125, v110 offset:1856
  v_lshlrev_b32 v126, 2, v126
  v_add_u32 v126, 122112, v126
  ds_write_b32 v126, v114 offset:3584
  v_and_b32 v124, 0xffff0000, v112
  v_lshlrev_b32 v122, 16, v122
  s_branch L_m_join
L_m_fw:
  v_lshlrev_b32 v10, 3, v1
  s_movk_i32 s62, 28672
  s_mov_b64 exec, 0xfffffff
  s_mov_b32 s30, 524288
L_m_xpoll:
  buffer_load_dwordx2 v[108:109], v10, s[16:19], s62 offen sc1
  s_sub_u32 s30, s30, 1
  s_cbranch_scc1 L_m_xpoll_x
  s_waitcnt vmcnt(0)
  v_cmp_ne_u32 vcc, s96, v109
  s_cbranch_vccnz L_m_xpoll
L_m_xpoll_x:
  s_waitcnt vmcnt(0)
  s_getreg_b32 s30, hwreg(HW_REG_XCC_ID)
  s_and_b32 s30, s30, 15
  v_cmp_ne_u32 vcc, s30, v108
  s_mov_b64 exec, -1
  s_cmp_eq_u64 vcc, 0
  s_mov_b32 s61, 360448
  s_cselect_b32 s60, 475136, s61
  v_mov_b32 v10, s60
  v_mov_b32 v11, 133888
  ds_write_b32 v11, v10
  s_sub_u32 s4, s3, 14
  v_and_b32 v10, 3, v2
  v_lshl_add_u32 v10, v10, 2, v3
  s_lshl_b32 s30, s5, 4
  s_mul_i32 s31, s4, 448
  s_add_u32 s30, s30, s31
  v_add_u32 v10, s30, v10
  v_lshlrev_b32 v11, 2, v10
  v_add_u32 v11, 122112, v11
  v_lshlrev_b32 v10, 1, v10
  v_lshrrev_b32 v12, 2, v1
  v_and_b32 v14, 3, v1
  v_lshlrev_b32 v14, 4, v14
  v_mul_u32_u24 v12, 3584, v12
  v_add_u32 v12, v12, v14
  v_add_u32 v13, 57344, v12
  v_cmp_gt_u32 vcc, 48, v1
  s_nop 1
  v_cndmask_b32 v13, v12, v13, vcc
  v_cndmask_b32 v28, 0, 1.0, vcc
  s_lshl_b32 s30, s5, 6
  s_mul_i32 s31, s4, 1792
  s_add_u32 s30, s30, s31
  s_add_u32 s60, s60, s30
  s_mov_b32 s24, s52
  s_mov_b32 s25, s53
  s_mov_b32 s26, 1792
  s_mov_b32 s27, 0x20000
L_m_join:
  s_waitcnt vmcnt(0) lgkmcnt(0)
  s_barrier
  s_cmp_ge_u32 s3, 14
  s_cbranch_scc1 L_m_bar1
  s_cmp_ge_u32 s3, 4
  s_cbranch_scc1 L_m_now1
  s_lshl_b32 s30, s3, 5
  v_xor_b32 v10, s30, v9
  ds_read_b64_tr_b16 v[16:17], v10 offset:0
  ds_read_b64_tr_b16 v[18:19], v10 offset:512
  ds_read_b64_tr_b16 v[20:21], v10 offset:4096
  ds_read_b64_tr_b16 v[22:23], v10 offset:4608
  ds_read_b64_tr_b16 v[24:25], v10 offset:8192
  ds_read_b64_tr_b16 v[26:27], v10 offset:8704
  ds_read_b64_tr_b16 v[28:29], v10 offset:12288
  ds_read_b64_tr_b16 v[30:31], v10 offset:12800
  ds_read_b64_tr_b16 v[32:33], v10 offset:16384
  ds_read_b64_tr_b16 v[34:35], v10 offset:16896
  ds_read_b64_tr_b16 v[36:37], v10 offset:20480
  ds_read_b64_tr_b16 v[38:39], v10 offset:20992
  ds_read_b64_tr_b16 v[40:41], v10 offset:24576
  ds_read_b64_tr_b16 v[42:43], v10 offset:25088
  ds_read_b64_tr_b16 v[44:45], v10 offset:28672
  ds_read_b64_tr_b16 v[46:47], v10 offset:29184
  ds_read_b64_tr_b16 v[48:49], v10 offset:32768
  ds_read_b64_tr_b16 v[50:51], v10 offset:33280
  ds_read_b64_tr_b16 v[52:53], v10 offset:36864
  ds_read_b64_tr_b16 v[54:55], v10 offset:37376
  ds_read_b64_tr_b16 v[56:57], v10 offset:40960
  ds_read_b64_tr_b16 v[58:59], v10 offset:41472
  ds_read_b64_tr_b16 v[60:61], v10 offset:45056
  ds_read_b64_tr_b16 v[62:63], v10 offset:45568
  ds_read_b64_tr_b16 v[64:65], v10 offset:49152
  ds_read_b64_tr_b16 v[66:67], v10 offset:49664
  ds_read_b64_tr_b16 v[68:69], v10 offset:53248
  ds_read_b64_tr_b16 v[70:71], v10 offset:53760
  v_and_b32 v15, 7, v2
  v_mul_u32_u24 v13, 928, v15
  v_lshl_add_u32 v13, v3, 4, v13
  v_add_u32 v13, 114688, v13
  v_lshlrev_b32 v8, 2, v1
  v_add_u32 v8, 122112, v8
  s_add_u32 s30, s30, 129280
  v_lshlrev_b32 v9, 1, v2
  v_mul_u32_u24 v15, 144, v3
  v_add3_u32 v9, v9, v15, s30
  s_branch L_m_pp
L_m_now1:
  s_cmp_ge_u32 s6, 7
  s_cbranch_scc1 L_m_pp
  v_add_u32 v12, s7, v9
  v_xor_b32 v13, 32, v12
  v_xor_b32 v14, 64, v12
  v_xor_b32 v15, 0x60, v12
  ds_read_b64_tr_b16 v[16:17], v12 offset:0
  ds_read_b64_tr_b16 v[18:19], v12 offset:512
  ds_read_b64_tr_b16 v[20:21], v13 offset:0
  ds_read_b64_tr_b16 v[22:23], v13 offset:512
  ds_read_b64_tr_b16 v[24:25], v14 offset:0
  ds_read_b64_tr_b16 v[26:27], v14 offset:512
  ds_read_b64_tr_b16 v[28:29], v15 offset:0
  ds_read_b64_tr_b16 v[30:31], v15 offset:512
  ds_read_b64_tr_b16 v[32:33], v12 offset:4096
  ds_read_b64_tr_b16 v[34:35], v12 offset:4608
  ds_read_b64_tr_b16 v[36:37], v13 offset:4096
  ds_read_b64_tr_b16 v[38:39], v13 offset:4608
  ds_read_b64_tr_b16 v[40:41], v14 offset:4096
  ds_read_b64_tr_b16 v[42:43], v14 offset:4608
  ds_read_b64_tr_b16 v[44:45], v15 offset:4096
  ds_read_b64_tr_b16 v[46:47], v15 offset:4608
  v_and_b32 v8, 1, v2
  v_mul_u32_u24 v8, 144, v8
  v_lshl_add_u32 v8, v3, 4, v8
  v_add_u32 v8, 129280, v8
  v_lshlrev_b32 v9, 2, v1
  v_mov_b32 v10, 133888
  ds_read_b32 v10, v10
  s_mul_i32 s60, s5, 3584
  s_lshl_b32 s61, s6, 8
  s_add_u32 s60, s60, s61
  s_waitcnt lgkmcnt(0)
  v_readfirstlane_b32 s61, v10
  s_add_u32 s60, s60, s61
  v_cmp_eq_u32 s[72:73], 1, v3
  v_cmp_eq_u32 s[74:75], 2, v3
  v_cmp_eq_u32 s[76:77], 3, v3
L_m_pp:
  v_mul_u32_u24 v10, 1792, v3
  v_lshl_add_u32 v10, v2, 4, v10
  s_mul_i32 s30, s4, 12544
  s_lshl_b32 s31, s3, 8
  s_add_u32 s30, s30, s31
  s_add_u32 s30, s30, 327680
  s_add_u32 s31, s30, 7168
  s_mov_b32 s62, 524288
L_m_poll:
  buffer_load_dwordx4 v[108:111], v10, s[16:19], s30 offen sc1
  buffer_load_dwordx4 v[112:115], v10, s[16:19], s31 offen sc1
  s_waitcnt vmcnt(0)
  v_max3_u32 v116, v108, v109, v110
  v_max3_u32 v117, v111, v112, v113
  v_max3_u32 v116, v116, v114, v115
  v_max_u32 v116, v116, v117
  v_cmp_eq_u32 vcc, -1, v116
  s_sub_u32 s62, s62, 1
  s_cbranch_scc1 L_m_got
  s_and_b64 exec, exec, vcc
  s_cbranch_execnz L_m_poll
L_m_got:
  s_mov_b64 exec, -1
  v_add_f32 v116, v108, v112
  v_add_f32 v117, v109, v113
  v_add_f32 v118, v110, v114
  v_add_f32 v119, v111, v115
  s_nop 0
  v_permlane32_swap_b32 v116, v118
  v_permlane32_swap_b32 v117, v119
  v_add_f32 v116, v116, v118
  v_add_f32 v117, v117, v119
  s_nop 1
  v_permlane16_swap_b32 v116, v117
  v_add_f32 v116, v116, v117
  v_fmac_f32 v122, v123, v116
  v_mul_f32 v117, v122, v124
  v_cvt_pk_bf16_f32 v117, v117, v117
  ds_write_b16 v125, v117
  ds_write_b32 v126, v122
L_m_bar1:
  s_waitcnt lgkmcnt(0)
  s_barrier
  s_cmp_ge_u32 s3, 4
  s_cbranch_scc1 L_m_bar2
  ds_read_b128 v[72:75], v13 offset:0
  ds_read_b128 v[76:79], v13 offset:64
  ds_read2st64_b32 v[108:109], v8 offset0:0 offset1:7
  ds_read2st64_b32 v[110:111], v8 offset0:1 offset1:8
  ds_read2st64_b32 v[112:113], v8 offset0:2 offset1:9
  ds_read2st64_b32 v[114:115], v8 offset0:3 offset1:10
  ds_read2st64_b32 v[116:117], v8 offset0:4 offset1:11
  ds_read2st64_b32 v[118:119], v8 offset0:5 offset1:12
  ds_read2st64_b32 v[120:121], v8 offset0:6 offset1:13
  ds_read_b128 v[80:83], v13 offset:128
  ds_read_b128 v[84:87], v13 offset:192
  ds_read_b128 v[88:91], v13 offset:256
  ds_read_b128 v[92:95], v13 offset:320
  ds_read_b128 v[96:99], v13 offset:384
  ds_read_b128 v[100:103], v13 offset:448
  s_waitcnt lgkmcnt(14)
  v_mfma_f32_16x16x32_bf16 v[104:107], v[72:75], v[16:19], 0
  ds_read_b128 v[72:75], v13 offset:512
  s_waitcnt lgkmcnt(14)
  v_mfma_f32_16x16x32_bf16 v[104:107], v[76:79], v[20:23], v[104:107]
  ds_read_b128 v[76:79], v13 offset:576
  s_waitcnt lgkmcnt(7)
  v_mfma_f32_16x16x32_bf16 v[104:107], v[80:83], v[24:27], v[104:107]
  ds_read_b128 v[80:83], v13 offset:640
  v_pk_add_f32 v[4:5], v[108:109], v[110:111]
  v_pk_mul_f32 v[6:7], v[108:109], v[108:109]
  v_pk_add_f32 v[4:5], v[4:5], v[112:113]
  v_pk_fma_f32 v[6:7], v[110:111], v[110:111], v[6:7]
  s_waitcnt lgkmcnt(7)
  v_mfma_f32_16x16x32_bf16 v[104:107], v[84:87], v[28:31], v[104:107]
  ds_read_b128 v[84:87], v13 offset:704
  v_pk_add_f32 v[4:5], v[4:5], v[114:115]
  v_pk_fma_f32 v[6:7], v[112:113], v[112:113], v[6:7]
  v_pk_add_f32 v[4:5], v[4:5], v[116:117]
  s_waitcnt lgkmcnt(7)
  v_mfma_f32_16x16x32_bf16 v[104:107], v[88:91], v[32:35], v[104:107]
  ds_read_b128 v[88:91], v13 offset:768
  v_pk_fma_f32 v[6:7], v[114:115], v[114:115], v[6:7]
  v_pk_add_f32 v[4:5], v[4:5], v[118:119]
  v_pk_fma_f32 v[6:7], v[116:117], v[116:117], v[6:7]
  s_waitcnt lgkmcnt(7)
  v_mfma_f32_16x16x32_bf16 v[104:107], v[92:95], v[36:39], v[104:107]
  ds_read_b128 v[92:95], v13 offset:832
  v_pk_add_f32 v[4:5], v[4:5], v[120:121]
  v_pk_fma_f32 v[6:7], v[118:119], v[118:119], v[6:7]
  v_pk_fma_f32 v[6:7], v[120:121], v[120:121], v[6:7]
  s_waitcnt lgkmcnt(7)
  v_mfma_f32_16x16x32_bf16 v[104:107], v[96:99], v[40:43], v[104:107]
  v_permlane32_swap_b32 v4, v6
  v_permlane32_swap_b32 v5, v7
  v_add_f32 v4, v4, v6
  v_add_f32 v5, v5, v7
  s_waitcnt lgkmcnt(6)
  v_mfma_f32_16x16x32_bf16 v[104:107], v[100:103], v[44:47], v[104:107]
  v_permlane16_swap_b32 v4, v5
  v_add_f32 v4, v4, v5
  s_waitcnt lgkmcnt(5)
  v_mfma_f32_16x16x32_bf16 v[104:107], v[72:75], v[48:51], v[104:107]
  v_add_f32_dpp v4, v4, v4 row_ror:1 row_mask:0xf bank_mask:0xf
  s_waitcnt lgkmcnt(4)
  v_mfma_f32_16x16x32_bf16 v[104:107], v[76:79], v[52:55], v[104:107]
  v_add_f32_dpp v4, v4, v4 row_ror:2 row_mask:0xf bank_mask:0xf
  s_waitcnt lgkmcnt(3)
  v_mfma_f32_16x16x32_bf16 v[104:107], v[80:83], v[56:59], v[104:107]
  v_add_f32_dpp v4, v4, v4 row_ror:4 row_mask:0xf bank_mask:0xf
  s_waitcnt lgkmcnt(2)
  v_mfma_f32_16x16x32_bf16 v[104:107], v[84:87], v[60:63], v[104:107]
  v_add_f32_dpp v4, v4, v4 row_ror:8 row_mask:0xf bank_mask:0xf
  s_waitcnt lgkmcnt(1)
  v_mfma_f32_16x16x32_bf16 v[104:107], v[88:91], v[64:67], v[104:107]
  v_mul_f32 v4, 0x3b124925, v4
  v_mov_b32 v5, v4
  s_nop 1
  v_permlane32_swap_b32 v4, v5
  s_waitcnt lgkmcnt(0)
  v_mfma_f32_16x16x32_bf16 v[104:107], v[92:95], v[68:71], v[104:107]
  v_fma_f32 v5, -v4, v4, v5
  v_max_f32 v5, 0, v5
  v_add_f32 v5, 0x3727c5ac, v5
  v_rsq_f32 v5, v5
  s_mov_b32 exec_hi, 0
  s_nop 2
  v_fma_f32 v104, -v4, v105, v104
  v_fma_f32 v104, v5, v104, v106
  v_mul_f32 v6, 0xbfb8aa3b, v104
  v_exp_f32 v6, v6
  s_nop 0
  v_add_f32 v6, 1.0, v6
  v_rcp_f32 v6, v6
  s_nop 0
  v_mul_f32 v6, v6, v104
  v_cvt_pk_bf16_f32 v6, v6, v6
  ds_write_b16 v9, v6
  s_mov_b64 exec, -1
L_m_bar2:
  s_waitcnt lgkmcnt(0)
  s_barrier
  s_cmp_ge_u32 s3, 14
  s_cbranch_scc1 L_final
  s_cmp_ge_u32 s6, 7
  s_cbranch_scc1 L_epoch
  ds_read_b128 v[48:51], v8
  ds_read_b128 v[52:55], v8 offset:64
  s_waitcnt lgkmcnt(1)
  v_mfma_f32_16x16x32_bf16 v[64:67], v[48:51], v[16:19], 0
  v_mfma_f32_16x16x32_bf16 v[68:71], v[48:51], v[20:23], 0
  v_mfma_f32_16x16x32_bf16 v[72:75], v[48:51], v[24:27], 0
  v_mfma_f32_16x16x32_bf16 v[76:79], v[48:51], v[28:31], 0
  s_waitcnt lgkmcnt(0)
  v_mfma_f32_16x16x32_bf16 v[64:67], v[52:55], v[32:35], v[64:67]
  v_mfma_f32_16x16x32_bf16 v[68:71], v[52:55], v[36:39], v[68:71]
  v_mfma_f32_16x16x32_bf16 v[72:75], v[52:55], v[40:43], v[72:75]
  v_mfma_f32_16x16x32_bf16 v[76:79], v[52:55], v[44:47], v[76:79]
  s_nop 5
  v_cndmask_b32 v64, v64, v68, s[72:73]
  v_cndmask_b32 v65, v65, v69, s[72:73]
  v_cndmask_b32 v64, v64, v72, s[74:75]
  v_cndmask_b32 v65, v65, v73, s[74:75]
  v_cndmask_b32 v64, v64, v76, s[76:77]
  v_cndmask_b32 v65, v65, v77, s[76:77]
  v_min_u32 v64, -2, v64
  v_min_u32 v65, -2, v65
  s_cmp_eq_u32 s61, 475136
  s_cbranch_scc0 L_m_glob
  buffer_store_dword v64, v9, s[16:19], s60 offen
  buffer_store_dword v65, v9, s[16:19], s60 offen offset:1792
  s_branch L_fin
L_m_glob:
  buffer_store_dword v64, v9, s[16:19], s60 offen sc1
  buffer_store_dword v65, v9, s[16:19], s60 offen offset:1792 sc1
  s_branch L_fin
L_epoch:
  s_or_b32 s30, s3, s5
  s_cmp_lg_u32 s30, 0
  s_cbranch_scc1 L_fin
  s_mov_b64 exec, 1
  v_mov_b32 v26, s96
  v_mov_b32 v27, 0
  buffer_store_dword v26, v27, s[16:19], 0 offen sc1
  s_mov_b64 exec, -1
  s_branch L_fin
L_final:
  ds_read_b32 v30, v11
  ds_read_b32 v31, v11 offset:3584
  s_mov_b32 s62, 524288
L_fin_poll:
  buffer_load_dwordx4 v[16:19], v12, s[16:19], s60 offen sc1
  buffer_load_dwordx4 v[20:23], v13, s[16:19], s60 offen sc1
  s_waitcnt vmcnt(0)
  v_max3_u32 v24, v16, v17, v18
  v_max3_u32 v25, v19, v20, v21
  v_max3_u32 v24, v24, v22, v23
  v_max_u32 v24, v24, v25
  v_cmp_eq_u32 vcc, -1, v24
  s_sub_u32 s62, s62, 1
  s_cbranch_scc1 L_fin_got
  s_and_b64 exec, exec, vcc
  s_cbranch_execnz L_fin_poll
L_fin_got:
  s_mov_b64 exec, -1
  v_fma_f32 v32, v20, v28, v16
  v_fma_f32 v33, v21, v28, v17
  v_fma_f32 v34, v22, v28, v18
  v_fma_f32 v35, v23, v28, v19
  s_nop 0
  v_permlane32_swap_b32 v32, v34
  v_permlane32_swap_b32 v33, v35
  v_add_f32 v32, v32, v34
  v_add_f32 v33, v33, v35
  s_nop 1
  v_permlane16_swap_b32 v32, v33
  v_add_f32 v32, v32, v33
  s_nop 1
  v_add_f32_dpp v32, v32, v32 row_ror:4 row_mask:0xf bank_mask:0xf
  s_nop 1
  v_add_f32_dpp v32, v32, v32 row_ror:8 row_mask:0xf bank_mask:0xf
  s_waitcnt lgkmcnt(0)
  v_fmac_f32 v30, v31, v32
  v_cvt_pk_bf16_f32 v30, v30, v30
  s_mov_b32 exec_lo, 0x000f000f
  s_mov_b32 exec_hi, 0x000f000f
  buffer_store_short v30, v10, s[24:27], 0 offen
  s_mov_b64 exec, -1
  s_branch L_fin
L_q_cont:
  s_load_dword s97, s[56:57], 0
  s_mov_b32 s16, s56
  s_mov_b32 s17, s57
  v_and_b32 v14, 1, v3
  v_lshlrev_b32 v14, 1, v14
  v_lshrrev_b32 v15, 2, v2
  v_lshl_add_u32 v9, v3, 3, v15
  v_lshlrev_b32 v9, 7, v9
  v_lshrrev_b32 v15, 1, v15
  v_or_b32 v15, v15, v14
  v_lshl_add_u32 v9, v15, 5, v9
  v_and_b32 v15, 3, v2
  v_lshl_add_u32 v9, v15, 3, v9
  v_and_b32 v15, 1, v2
  v_mul_u32_u24 v13, 3712, v15
  v_lshl_add_u32 v13, v3, 4, v13
  v_add_u32 v13, 117472, v13
  v_lshlrev_b32 v11, 6, v2
  v_lshl_add_u32 v11, v3, 4, v11
  s_and_b32 s30, s3, 3
  s_lshl_b32 s31, s30, 5
  v_xor_b32 v10, s31, v9
  s_lshr_b32 s62, s3, 2
  s_mul_i32 s31, s62, s67
  s_lshl_b32 s31, s31, 10
  v_add_u32 v10, s31, v10
  s_lshl_b32 s31, s66, 6
  v_add_u32 v13, s31, v13
  s_lshl3_add_u32 s31, s62, s64
  s_lshl_b32 s31, s31, 9
  s_lshl_b32 s30, s30, 7
  s_add_u32 s31, s31, s30
  s_cmp_lg_u32 s66, 0
  s_cselect_b32 s30, 0x8000, 0
  s_add_u32 s31, s31, s30
  s_add_u32 s31, s31, 589824
  s_mov_b32 s7, 1
  s_waitcnt vmcnt(0) lgkmcnt(0)
  s_mul_i32 s96, s97, 0x9E3779B1
  s_add_u32 s96, s96, 0x7F4A7C15
  s_barrier
  s_cmp_lt_u32 s3, 4
  s_cbranch_scc1 L_front_gemv
  s_cmp_lg_u32 s66, 0
  s_cbranch_scc1 L_front_gemv
  s_barrier
  s_branch L_q_done
L_qa_cont:
  s_load_dword s97, s[56:57], 0
  s_mov_b32 s16, s56
  s_mov_b32 s17, s57
  s_cmp_lg_u32 s3, 8
  s_cbranch_scc1 L_q_nopre
  s_cmp_lg_u32 s66, 0
  s_cbranch_scc1 L_q_nopre
  v_mov_b32 v28, -1
  v_mov_b32 v29, -1
  v_mov_b32 v30, -1
  v_mov_b32 v31, -1
  v_lshlrev_b32 v12, 4, v1
  s_lshl_b32 s63, s64, 12
  s_add_u32 s63, s63, 65536
  buffer_store_dwordx4 v[28:31], v12, s[16:19], s63 offen offset:0 sc1
  buffer_store_dwordx4 v[28:31], v12, s[16:19], s63 offen offset:1024 sc1
  buffer_store_dwordx4 v[28:31], v12, s[16:19], s63 offen offset:2048 sc1
  buffer_store_dwordx4 v[28:31], v12, s[16:19], s63 offen offset:3072 sc1
  s_waitcnt vmcnt(0) lgkmcnt(0)
  s_mul_i32 s96, s97, 0x9E3779B1
  s_add_u32 s96, s96, 0x7F4A7C15
  v_mov_b32 v29, s96
  s_lshl_b32 s63, s64, 3
  s_add_u32 s63, s63, 32256
  s_mov_b64 exec, 1
  buffer_store_dwordx2 v[28:29], v12, s[16:19], s63 offen sc1
  s_mov_b64 exec, -1
L_q_nopre:
  v_and_b32 v12, 7, v4
  v_lshrrev_b32 v4, 3, v4
  v_lshlrev_b32 v4, 7, v4
  v_lshl_add_u32 v4, v12, 3, v4
  s_mul_i32 s63, s30, 3712
  s_add_u32 s63, s63, 117472
  v_add_u32 v6, s63, v5
  s_lshl_b32 s62, s30, 6
  s_add_u32 s62, s62, 4096
  s_add_u32 s63, s62, 28672
  s_waitcnt vmcnt(1)
  v_lshlrev_b32 v32, 16, v16
  v_and_b32 v33, 0xffff0000, v16
  v_lshlrev_b32 v34, 16, v17
  v_and_b32 v35, 0xffff0000, v17
  v_lshlrev_b32 v36, 16, v18
  v_and_b32 v37, 0xffff0000, v18
  v_lshlrev_b32 v38, 16, v19
  v_and_b32 v39, 0xffff0000, v19
  v_add_f32 v48, v32, v33
  v_add_f32 v48, v48, v34
  v_add_f32 v48, v48, v35
  v_add_f32 v48, v48, v36
  v_add_f32 v48, v48, v37
  v_add_f32 v48, v48, v38
  v_add_f32 v48, v48, v39
  s_nop 1
  v_add_f32_dpp v48, v48, v48 row_ror:1 row_mask:0xf bank_mask:0xf
  s_nop 1
  v_add_f32_dpp v48, v48, v48 row_ror:2 row_mask:0xf bank_mask:0xf
  s_nop 1
  v_add_f32_dpp v48, v48, v48 row_ror:4 row_mask:0xf bank_mask:0xf
  s_nop 1
  v_add_f32_dpp v48, v48, v48 row_ror:8 row_mask:0xf bank_mask:0xf
  v_mov_b32 v50, v48
  s_nop 1
  v_permlane16_swap_b32 v50, v48
  v_add_f32 v48, v48, v50
  v_mov_b32 v50, v48
  s_nop 1
  v_permlane32_swap_b32 v50, v48
  v_add_f32 v48, v48, v50
  v_mul_f32 v48, 0x3b124925, v48
  v_sub_f32 v32, v32, v48
  v_sub_f32 v33, v33, v48
  v_sub_f32 v34, v34, v48
  v_sub_f32 v35, v35, v48
  v_sub_f32 v36, v36, v48
  v_sub_f32 v37, v37, v48
  v_sub_f32 v38, v38, v48
  v_sub_f32 v39, v39, v48
  v_mul_f32 v52, v32, v32
  v_fmac_f32 v52, v33, v33
  v_fmac_f32 v52, v34, v34
  v_fmac_f32 v52, v35, v35
  v_fmac_f32 v52, v36, v36
  v_fmac_f32 v52, v37, v37
  v_fmac_f32 v52, v38, v38
  v_fmac_f32 v52, v39, v39
  v_cndmask_b32 v52, 0, v52, s[70:71]
  s_nop 1
  v_add_f32_dpp v52, v52, v52 row_ror:1 row_mask:0xf bank_mask:0xf
  s_nop 1
  v_add_f32_dpp v52, v52, v52 row_ror:2 row_mask:0xf bank_mask:0xf
  s_nop 1
  v_add_f32_dpp v52, v52, v52 row_ror:4 row_mask:0xf bank_mask:0xf
  s_nop 1
  v_add_f32_dpp v52, v52, v52 row_ror:8 row_mask:0xf bank_mask:0xf
  v_mov_b32 v50, v52
  s_nop 1
  v_permlane16_swap_b32 v50, v52
  v_add_f32 v52, v52, v50
  v_mov_b32 v50, v52
  s_nop 1
  v_permlane32_swap_b32 v50, v52
  v_add_f32 v52, v52, v50
  v_mov_b32 v54, 0x3727c5ac
  v_fmac_f32 v54, 0x3b124925, v52
  v_rsq_f32 v54, v54
  s_waitcnt lgkmcnt(0)
  s_mul_i32 s96, s97, 0x9E3779B1
  s_add_u32 s96, s96, 0x7F4A7C15
  s_barrier
  s_mov_b64 exec, s[70:71]
  s_mov_b32 s30, 524288
L_q_poll:
  buffer_load_dwordx2 v[100:101], v4, s[16:19], s62 offen sc1
  buffer_load_dwordx2 v[102:103], v4, s[16:19], s62 offen offset:3584 sc1
  buffer_load_dwordx2 v[104:105], v4, s[16:19], s63 offen sc1
  buffer_load_dwordx2 v[106:107], v4, s[16:19], s63 offen offset:3584 sc1
  s_sub_u32 s30, s30, 1
  s_cbranch_scc1 L_q_poll_x
  s_waitcnt vmcnt(0)
  v_cmp_ne_u32 vcc, s96, v101
  v_cmp_ne_u32 s[28:29], s96, v103
  s_or_b64 vcc, vcc, s[28:29]
  v_cmp_ne_u32 s[28:29], s96, v105
  s_or_b64 vcc, vcc, s[28:29]
  v_cmp_ne_u32 s[28:29], s96, v107
  s_or_b64 vcc, vcc, s[28:29]
  s_cbranch_vccnz L_q_poll
L_q_poll_x:
  s_waitcnt vmcnt(0)
  v_and_b32 v25, 0xffff0000, v24
  v_lshlrev_b32 v24, 16, v24
  v_sub_f32 v24, v24, v48
  v_sub_f32 v25, v25, v48
  v_mul_f32 v112, v24, v54
  v_mul_f32 v113, v25, v54
  v_lshlrev_b32 v114, 16, v102
  v_and_b32 v115, 0xffff0000, v102
  v_lshlrev_b32 v116, 16, v106
  v_and_b32 v117, 0xffff0000, v106
  v_add_f32 v114, 1.0, v114
  v_add_f32 v115, 1.0, v115
  v_add_f32 v114, v114, v116
  v_add_f32 v115, v115, v117
  v_lshlrev_b32 v110, 16, v100
  v_and_b32 v111, 0xffff0000, v100
  v_lshlrev_b32 v116, 16, v104
  v_and_b32 v117, 0xffff0000, v104
  v_add_f32 v110, v110, v116
  v_add_f32 v111, v111, v117
  v_fmac_f32 v110, v112, v114
  v_fmac_f32 v111, v113, v115
  v_cvt_pk_bf16_f32 v110, v110, v111
  ds_write_b32 v6, v110
  s_mov_b64 exec, -1
  s_waitcnt lgkmcnt(0)
  s_barrier
  s_branch L_q_done
L_front_gemv:
  ds_read_b64_tr_b16 v[16:17], v10 offset:0
  ds_read_b64_tr_b16 v[18:19], v10 offset:512
  ds_read_b64_tr_b16 v[20:21], v10 offset:4096
  ds_read_b64_tr_b16 v[22:23], v10 offset:4608
  ds_read_b64_tr_b16 v[24:25], v10 offset:8192
  ds_read_b64_tr_b16 v[26:27], v10 offset:8704
  ds_read_b64_tr_b16 v[28:29], v10 offset:12288
  ds_read_b64_tr_b16 v[30:31], v10 offset:12800
  ds_read_b64_tr_b16 v[32:33], v10 offset:16384
  ds_read_b64_tr_b16 v[34:35], v10 offset:16896
  s_cmp_eq_u32 s65, 5
  s_cbranch_scc1 L_fg_rd
  ds_read_b64_tr_b16 v[36:37], v10 offset:20480
  ds_read_b64_tr_b16 v[38:39], v10 offset:20992
  ds_read_b64_tr_b16 v[40:41], v10 offset:24576
  ds_read_b64_tr_b16 v[42:43], v10 offset:25088
  s_cmp_eq_u32 s65, 7
  s_cbranch_scc1 L_fg_rd
  ds_read_b64_tr_b16 v[44:45], v10 offset:28672
  ds_read_b64_tr_b16 v[46:47], v10 offset:29184
  ds_read_b64_tr_b16 v[48:49], v10 offset:32768
  ds_read_b64_tr_b16 v[50:51], v10 offset:33280
  s_cmp_eq_u32 s65, 9
  s_cbranch_scc1 L_fg_rd
  ds_read_b64_tr_b16 v[52:53], v10 offset:36864
  ds_read_b64_tr_b16 v[54:55], v10 offset:37376
  ds_read_b64_tr_b16 v[56:57], v10 offset:40960
  ds_read_b64_tr_b16 v[58:59], v10 offset:41472
  ds_read_b64_tr_b16 v[60:61], v10 offset:45056
  ds_read_b64_tr_b16 v[62:63], v10 offset:45568
  ds_read_b64_tr_b16 v[64:65], v10 offset:49152
  ds_read_b64_tr_b16 v[66:67], v10 offset:49664
  ds_read_b64_tr_b16 v[68:69], v10 offset:53248
  ds_read_b64_tr_b16 v[70:71], v10 offset:53760
L_fg_rd:
  v_mov_b32 v109, s96
  v_mov_b32 v111, s96
  s_cmp_lg_u32 s7, 1
  s_cbranch_scc1 L_fg_a
  s_barrier
L_fg_a:
  ds_read_b128 v[72:75], v13 offset:0
  ds_read_b128 v[76:79], v13 offset:64
  ds_read_b128 v[80:83], v13 offset:128
  ds_read_b128 v[84:87], v13 offset:192
  ds_read_b128 v[88:91], v13 offset:256
  ds_read_b128 v[92:95], v13 offset:320
  ds_read_b128 v[96:99], v13 offset:384
  ds_read_b128 v[100:103], v13 offset:448
  s_waitcnt lgkmcnt(7)
  v_mfma_f32_16x16x32_bf16 v[104:107], v[16:19], v[72:75], 0
  ds_read_b128 v[72:75], v13 offset:512
  s_waitcnt lgkmcnt(7)
  v_mfma_f32_16x16x32_bf16 v[104:107], v[20:23], v[76:79], v[104:107]
  ds_read_b128 v[76:79], v13 offset:576
  s_waitcnt lgkmcnt(7)
  v_mfma_f32_16x16x32_bf16 v[104:107], v[24:27], v[80:83], v[104:107]
  ds_read_b128 v[80:83], v13 offset:640
  s_waitcnt lgkmcnt(7)
  v_mfma_f32_16x16x32_bf16 v[104:107], v[28:31], v[84:87], v[104:107]
  ds_read_b128 v[84:87], v13 offset:704
  s_waitcnt lgkmcnt(7)
  v_mfma_f32_16x16x32_bf16 v[104:107], v[32:35], v[88:91], v[104:107]
  ds_read_b128 v[88:91], v13 offset:768
  s_cmp_eq_u32 s65, 5
  s_nop 2
  s_cbranch_scc1 L_fg_out
  s_waitcnt lgkmcnt(7)
  v_mfma_f32_16x16x32_bf16 v[104:107], v[36:39], v[92:95], v[104:107]
  ds_read_b128 v[92:95], v13 offset:832
  s_waitcnt lgkmcnt(7)
  v_mfma_f32_16x16x32_bf16 v[104:107], v[40:43], v[96:99], v[104:107]
  s_cmp_eq_u32 s65, 7
  s_nop 3
  s_cbranch_scc1 L_fg_out
  s_waitcnt lgkmcnt(6)
  v_mfma_f32_16x16x32_bf16 v[104:107], v[44:47], v[100:103], v[104:107]
  s_waitcnt lgkmcnt(5)
  v_mfma_f32_16x16x32_bf16 v[104:107], v[48:51], v[72:75], v[104:107]
  s_cmp_eq_u32 s65, 9
  s_nop 3
  s_cbranch_scc1 L_fg_out
  s_waitcnt lgkmcnt(4)
  v_mfma_f32_16x16x32_bf16 v[104:107], v[52:55], v[76:79], v[104:107]
  s_waitcnt lgkmcnt(3)
  v_mfma_f32_16x16x32_bf16 v[104:107], v[56:59], v[80:83], v[104:107]
  s_waitcnt lgkmcnt(2)
  v_mfma_f32_16x16x32_bf16 v[104:107], v[60:63], v[84:87], v[104:107]
  s_waitcnt lgkmcnt(1)
  v_mfma_f32_16x16x32_bf16 v[104:107], v[64:67], v[88:91], v[104:107]
  s_waitcnt lgkmcnt(0)
  v_mfma_f32_16x16x32_bf16 v[104:107], v[68:71], v[92:95], v[104:107]
L_fg_out:
  s_mov_b32 exec_lo, 0x00030003
  s_mov_b32 exec_hi, 0x00030003
  s_nop 5
  v_cvt_pk_bf16_f32 v108, v104, v105
  v_cvt_pk_bf16_f32 v110, v106, v107
  buffer_store_dwordx4 v[108:111], v11, s[16:19], s31 offen sc1
  s_mov_b64 exec, -1
  s_waitcnt lgkmcnt(0)
  s_cmp_eq_u32 s7, 3
  s_cbranch_scc1 L_m_ret2
  s_cmp_eq_u32 s7, 2
  s_cbranch_scc1 L_m_ret
L_q_done:
  s_cmp_lt_u32 s24, 224
  s_cbranch_scc1 L_att
L_fin:
L_exit:
  s_endpgm
.section .rodata,"a"
.p2align 6
.amdhsa_kernel adaLN_cond__sliding_block_cached__dense_activation_silu__decode_kernel
  .amdhsa_next_free_vgpr 128
  .amdhsa_next_free_sgpr 100
  .amdhsa_accum_offset 128
  .amdhsa_group_segment_fixed_size 0
  .amdhsa_kernarg_size 104
  .amdhsa_user_sgpr_count 2
  .amdhsa_user_sgpr_kernarg_segment_ptr 1
  .amdhsa_system_sgpr_workgroup_id_x 1
.end_amdhsa_kernel
```
